```python
import torch

def _softmax(x, axis=-1):
    return torch.softmax(x, dim=axis)
def _gelu(x):
    return torch.nn.functional.gelu(x, approximate="tanh")
def _silu(x):
    return torch.nn.functional.silu(x)
def _sigmoid(x):
    return torch.sigmoid(x)
def _layernorm(x, axis=-1, eps=1e-5):
    m = x.mean(dim=axis, keepdim=True)
    v = x.var(dim=axis, keepdim=True, unbiased=False)
    return (x - m) / torch.sqrt(v + eps)
def _scatter_add(tgt, idx, src, axis=0):
    return tgt.clone().index_add_(axis, idx, src)
def _segment_sum(src, seg, n):
    out = torch.zeros((n,) + src.shape[1:], dtype=src.dtype)
    return out.index_add_(0, seg, src)
def _pad(x, pw):
    flat = tuple(v for pair in reversed(pw) for v in pair)
    return torch.nn.functional.pad(x, flat)

kernel_name = 'sequential_preLN__spectral_gfnet__dense_activation_squared_relu__prompt'

def setup_inputs():

    _w = (lambda a: (lambda t: t.to(torch.bfloat16) if t.is_floating_point() else t)(torch.as_tensor(a)))
    def _A_setup():
        B, S, D = 1, 2048, 640
        Df = D // 2 + 1
        return {
            "x": _w((lambda *s: torch.randn(*s, dtype=torch.bfloat16) * 0.05)(B, S, D)),
            "w_r": _w((lambda *s: torch.randn(*s, dtype=torch.bfloat16) * 0.4)(S, Df) * 0.02),
            "w_i": _w((lambda *s: torch.randn(*s, dtype=torch.bfloat16) * 0.4)(S, Df) * 0.02),
        }
    _A_in = _A_setup()

    def _B_setup():
        B, S, D, F = 1, 2048, 640, 1728
        return {
            "x": _w((lambda *s: torch.randn(*s, dtype=torch.bfloat16) * 0.05)(B, S, D)),
            "w1": _w((lambda *s: torch.randn(*s, dtype=torch.bfloat16) * 0.05)(D, F)),
            "b1": _w((lambda *s: torch.randn(*s, dtype=torch.bfloat16) * 0.2)(F)),
            "w2": _w((lambda *s: torch.randn(*s, dtype=torch.bfloat16) * 0.05)(F, D)),
            "b2": _w((lambda *s: torch.randn(*s, dtype=torch.bfloat16) * 1.6)(D)),
        }
    _B_in = _B_setup()

    return {
        "A_x": _A_in["x"],
        "A_w_r": _A_in["w_r"],
        "A_w_i": _A_in["w_i"],
        "B_x": _B_in["x"],
        "B_w1": _B_in["w1"],
        "B_b1": _B_in["b1"],
        "B_w2": _B_in["w2"],
        "B_b2": _B_in["b2"],
    }

def reference(A_x, A_w_r, A_w_i, B_x, B_w1, B_b1, B_w2, B_b2):
    def _A_ref(x, w_r, w_i):
        B, S, D = x.shape
        X = (lambda x, axes=(-2,-1): torch.fft.rfft2(x.float(), dim=axes))(x, axes=(-2, -1))
        W = w_r + 1j * w_i
        X = X * W
        y = (lambda x, s, axes=(-2,-1): torch.fft.irfft2(x, s=s, dim=axes).to(torch.bfloat16))(X, (S, D), axes=(-2, -1))
        return y

    def _B_ref(x, w1, b1, w2, b2):
        h = torch.einsum("bsd,df->bsf", x, w1) + b1
        zero = torch.zeros_like(h)
        r = torch.where(h > zero, h, zero)
        h = r * r
        out = torch.einsum("bsf,fd->bsd", h, w2) + b2
        return out

    x = A_x
    h = x + _A_ref(_layernorm(x, axis=-1), A_w_r, A_w_i)
    h2 = h + _B_ref(_layernorm(h, axis=-1), B_w1, B_b1, B_w2, B_b2)
    return h2
```

```asm
; @launch kernel=k1_kernel grid=(588,1,1) block=(256,1,1) lds=21504
; @launch kernel=k3_kernel grid=(256,1,1) block=(256,1,1) lds=163840
.amdgcn_target "amdgcn-amd-amdhsa--gfx950"
.text
.globl k1_kernel
.p2align 8
.type k1_kernel,@function
k1_kernel:
  s_load_dwordx2 s[4:5], s[0:1], 0
  s_load_dwordx2 s[6:7], s[0:1], 80
  s_load_dwordx4 s[8:11], s[0:1], 8
  s_getpc_b64 s[60:61]
Lpc_k1_kernel_3:
  s_add_u32 s60, s60, k1_kernel-Lpc_k1_kernel_3
  s_addc_u32 s61, s61, -1
  s_sub_u32 s62, s2, 0
  s_cmp_lt_u32 s62, 8
  s_cselect_b32 s62, text_end-k1_kernel, 0
  s_mov_b32 s63, 0x20000
  v_lshlrev_b32 v160, 7, v0
  buffer_load_dword v160, v160, s[60:63], 0 offen
  s_cmp_ge_u32 s2, 256
  s_cbranch_scc1 K1_side
  s_lshr_b32 s22, s2, 3
  s_and_b32 s21, s22, 3
  s_lshr_b32 s22, s22, 2
  s_and_b32 s20, s2, 7
  s_lshl_b32 s20, s20, 2
  s_and_b32 s23, s22, 3
  s_add_u32 s20, s20, s23
  s_lshr_b32 s22, s22, 2
  s_lshl_b32 s22, s22, 2
  s_add_u32 s21, s21, s22
  s_lshl_b32 s22, s21, 8
  s_add_u32 s22, s22, s20
  s_mul_i32 s23, s22, 1280
  s_lshl_b32 s24, s20, 8
  s_lshl_b32 s22, s21, 5
  s_add_u32 s24, s24, s22
  s_add_u32 s26, s24, 1048576
  s_add_u32 s27, s24, 2097152
  v_lshrrev_b32 v1, 5, v0
  v_and_b32 v2, 31, v0
  v_mul_u32_u24 v3, 40960, v1
  v_lshl_add_u32 v3, v2, 3, v3
  v_and_b32 v5, 15, v0
  v_bfe_u32 v6, v0, 4, 2
  v_lshrrev_b32 v7, 6, v0
  v_cvt_f32_u32 v80, v5
  v_cvt_f32_u32 v81, v6
  v_mul_f32 v81, 4.0, v81
  v_mul_f32 v82, 0x3d4ccccd, v80
  v_mul_f32 v68, v82, v81
  v_add_f32 v69, v68, v82
  v_add_f32 v70, v69, v82
  v_add_f32 v71, v70, v82
  v_mul_f32 v72, 0x41800000, v82
  v_add_f32 v73, v72, v82
  v_add_f32 v74, v73, v82
  v_add_f32 v75, v74, v82
  v_cos_f32 v76, v68
  v_cos_f32 v77, v69
  v_sin_f32_e64 v78, -v68
  v_sin_f32_e64 v79, -v69
  v_cvt_pk_bf16_f32 v20, v76, v77
  v_cvt_pk_bf16_f32 v24, v78, v79
  v_cos_f32 v76, v70
  v_cos_f32 v77, v71
  v_sin_f32_e64 v78, -v70
  v_sin_f32_e64 v79, -v71
  v_cvt_pk_bf16_f32 v21, v76, v77
  v_cvt_pk_bf16_f32 v25, v78, v79
  v_cos_f32 v76, v72
  v_cos_f32 v77, v73
  v_sin_f32_e64 v78, -v72
  v_sin_f32_e64 v79, -v73
  v_cvt_pk_bf16_f32 v22, v76, v77
  v_cvt_pk_bf16_f32 v26, v78, v79
  v_cos_f32 v76, v74
  v_cos_f32 v77, v75
  v_sin_f32_e64 v78, -v74
  v_sin_f32_e64 v79, -v75
  v_cvt_pk_bf16_f32 v23, v76, v77
  v_cvt_pk_bf16_f32 v27, v78, v79
  s_waitcnt lgkmcnt(0)
  s_mov_b32 s12, s4
  s_mov_b32 s13, s5
  s_mov_b32 s14, 2621440
  s_mov_b32 s15, 0x20000
  buffer_load_dwordx2 v[8:9], v3, s[12:15], s23 offen offset:0
  buffer_load_dwordx2 v[10:11], v3, s[12:15], s23 offen offset:256
  buffer_load_dwordx2 v[12:13], v3, s[12:15], s23 offen offset:512
  buffer_load_dwordx2 v[14:15], v3, s[12:15], s23 offen offset:768
  buffer_load_dwordx2 v[16:17], v3, s[12:15], s23 offen offset:1024
  s_mov_b32 s16, s6
  s_mov_b32 s17, s7
  s_mov_b32 s18, 2629632
  s_mov_b32 s19, 0x20000
  s_mov_b32 exec_lo, 0xffff0000
  s_mov_b32 exec_hi, 0xffffffff
  v_mov_b32 v22, 0
  v_mov_b32 v23, 0
  v_mov_b32 v26, 0
  v_mov_b32 v27, 0
  s_mov_b64 exec, -1
  v_mul_f32 v82, 0x3acccccd, v80
  v_mul_f32 v68, v82, v81
  v_add_f32 v69, v68, v82
  v_add_f32 v70, v69, v82
  v_add_f32 v71, v70, v82
  v_fmamk_f32 v72, v82, 0x41800000, v68
  v_fmamk_f32 v73, v82, 0x41800000, v69
  v_fmamk_f32 v74, v82, 0x41800000, v70
  v_fmamk_f32 v75, v82, 0x41800000, v71
  v_cos_f32 v28, v68
  v_sin_f32 v36, v68
  v_cos_f32 v29, v69
  v_sin_f32 v37, v69
  v_cos_f32 v30, v70
  v_sin_f32 v38, v70
  v_cos_f32 v31, v71
  v_sin_f32 v39, v71
  v_cos_f32 v32, v72
  v_sin_f32 v40, v72
  v_cos_f32 v33, v73
  v_sin_f32 v41, v73
  v_cos_f32 v34, v74
  v_sin_f32 v42, v74
  v_cos_f32 v35, v75
  v_sin_f32 v43, v75
  v_mul_f32 v82, 0x3d000000, v80
  v_mul_f32 v68, v82, v81
  v_add_f32 v69, v68, v82
  v_add_f32 v70, v69, v82
  v_add_f32 v71, v70, v82
  v_fmamk_f32 v72, v82, 0x41800000, v68
  v_fmamk_f32 v73, v82, 0x41800000, v69
  v_fmamk_f32 v74, v82, 0x41800000, v70
  v_fmamk_f32 v75, v82, 0x41800000, v71
  v_cos_f32 v76, v68
  v_cos_f32 v77, v69
  v_sin_f32 v78, v68
  v_sin_f32 v79, v69
  v_cvt_pk_bf16_f32 v44, v76, v77
  v_cvt_pk_bf16_f32 v48, v78, v79
  v_cos_f32 v76, v70
  v_cos_f32 v77, v71
  v_sin_f32 v78, v70
  v_sin_f32 v79, v71
  v_cvt_pk_bf16_f32 v45, v76, v77
  v_cvt_pk_bf16_f32 v49, v78, v79
  v_cos_f32 v76, v72
  v_cos_f32 v77, v73
  v_sin_f32 v78, v72
  v_sin_f32 v79, v73
  v_cvt_pk_bf16_f32 v46, v76, v77
  v_cvt_pk_bf16_f32 v50, v78, v79
  v_cos_f32 v76, v74
  v_cos_f32 v77, v75
  v_sin_f32 v78, v74
  v_sin_f32 v79, v75
  v_cvt_pk_bf16_f32 v47, v76, v77
  v_cvt_pk_bf16_f32 v51, v78, v79
  v_xor_b32 v52, 0x80008000, v48
  v_xor_b32 v56, 0x80000000, v44
  v_xor_b32 v60, 0x80000000, v48
  v_xor_b32 v64, 0x00008000, v44
  v_xor_b32 v53, 0x80008000, v49
  v_xor_b32 v57, 0x80000000, v45
  v_xor_b32 v61, 0x80000000, v49
  v_xor_b32 v65, 0x00008000, v45
  v_xor_b32 v54, 0x80008000, v50
  v_xor_b32 v58, 0x80000000, v46
  v_xor_b32 v62, 0x80000000, v50
  v_xor_b32 v66, 0x00008000, v46
  v_xor_b32 v55, 0x80008000, v51
  v_xor_b32 v59, 0x80000000, v47
  v_xor_b32 v63, 0x80000000, v51
  v_xor_b32 v67, 0x00008000, v47
  v_mul_u32_u24 v83, 1280, v1
  v_lshl_add_u32 v83, v2, 3, v83
  v_mul_u32_u24 v84, 2560, v7
  v_and_b32 v90, 3, v0
  v_lshl_add_u32 v84, v90, 3, v84
  v_bfe_u32 v90, v0, 2, 2
  v_lshl_add_u32 v84, v90, 6, v84
  v_add_u32 v85, 1024, v84
  v_lshl_add_u32 v84, v6, 8, v84
  v_mul_u32_u24 v86, 2816, v7
  v_add_u32 v86, 10240, v86
  v_mad_u32_u24 v90, v6, 5, 0
  v_lshl_add_u32 v90, v90, 4, v5
  v_lshlrev_b32 v90, 2, v90
  v_sub_u32 v87, v86, v90
  v_add_u32 v87, 1040, v87
  v_add_u32 v86, v86, v90
  v_and_b32 v90, 1, v0
  v_lshrrev_b32 v88, 1, v0
  v_lshlrev_b32 v89, 13, v88
  v_lshl_add_u32 v89, v90, 4, v89
  v_mul_u32_u24 v90, 324, v90
  v_add_u32 v88, v88, v90
  v_lshlrev_b32 v88, 2, v88
  v_add_u32 v88, 10240, v88
  v_mov_b32 v93, 0x3f803f80
  v_mov_b32 v91, 0
  v_mov_b32 v92, 0
  s_waitcnt vmcnt(0)
  v_dot2c_f32_bf16 v91, v8, v93
  v_dot2c_f32_bf16 v92, v8, v8
  v_dot2c_f32_bf16 v91, v9, v93
  v_dot2c_f32_bf16 v92, v9, v9
  v_dot2c_f32_bf16 v91, v10, v93
  v_dot2c_f32_bf16 v92, v10, v10
  v_dot2c_f32_bf16 v91, v11, v93
  v_dot2c_f32_bf16 v92, v11, v11
  v_dot2c_f32_bf16 v91, v12, v93
  v_dot2c_f32_bf16 v92, v12, v12
  v_dot2c_f32_bf16 v91, v13, v93
  v_dot2c_f32_bf16 v92, v13, v13
  v_dot2c_f32_bf16 v91, v14, v93
  v_dot2c_f32_bf16 v92, v14, v14
  v_dot2c_f32_bf16 v91, v15, v93
  v_dot2c_f32_bf16 v92, v15, v15
  v_dot2c_f32_bf16 v91, v16, v93
  v_dot2c_f32_bf16 v92, v16, v16
  v_dot2c_f32_bf16 v91, v17, v93
  v_dot2c_f32_bf16 v92, v17, v17
  v_lshlrev_b32 v96, 16, v8
  v_and_b32 v97, 0xffff0000, v8
  v_lshlrev_b32 v98, 16, v9
  v_and_b32 v99, 0xffff0000, v9
  v_permlane16_swap_b32 v91, v92
  v_add_f32 v91, v91, v92
  v_lshlrev_b32 v100, 16, v10
  v_and_b32 v101, 0xffff0000, v10
  v_add_f32_dpp v91, v91, v91 row_ror:8 row_mask:0xf bank_mask:0xf
  v_lshlrev_b32 v102, 16, v11
  v_and_b32 v103, 0xffff0000, v11
  v_add_f32_dpp v91, v91, v91 row_ror:4 row_mask:0xf bank_mask:0xf
  v_lshlrev_b32 v104, 16, v12
  v_and_b32 v105, 0xffff0000, v12
  v_add_f32_dpp v91, v91, v91 row_ror:2 row_mask:0xf bank_mask:0xf
  v_lshlrev_b32 v106, 16, v13
  v_and_b32 v107, 0xffff0000, v13
  v_add_f32_dpp v91, v91, v91 row_ror:1 row_mask:0xf bank_mask:0xf
  v_mov_b32 v92, v91
  v_lshlrev_b32 v108, 16, v14
  v_and_b32 v109, 0xffff0000, v14
  v_lshlrev_b32 v110, 16, v15
  v_and_b32 v111, 0xffff0000, v15
  v_permlane16_swap_b32 v91, v92
  v_lshlrev_b32 v112, 16, v16
  v_and_b32 v113, 0xffff0000, v16
  v_lshlrev_b32 v114, 16, v17
  v_and_b32 v115, 0xffff0000, v17
  v_mul_f32 v91, 0x3acccccd, v91
  v_mul_f32 v92, 0x3acccccd, v92
  v_fma_f32 v92, -v91, v91, v92
  v_max_f32 v92, 0, v92
  v_cvt_pk_bf16_f32 v76, v91, v91
  v_lshlrev_b32 v76, 16, v76
  v_cvt_pk_bf16_f32 v92, v92, v92
  v_lshlrev_b32 v92, 16, v92
  v_add_f32 v92, 0x3727c5ac, v92
  v_cvt_pk_bf16_f32 v92, v92, v92
  v_lshlrev_b32 v92, 16, v92
  v_sqrt_f32 v92, v92
  s_nop 0
  v_cvt_pk_bf16_f32 v92, v92, v92
  v_lshlrev_b32 v92, 16, v92
  v_rcp_f32 v116, v92
  s_nop 0
  v_mul_f32_e64 v117, -v76, v116
  v_pk_fma_f32 v[96:97], v[96:97], v[116:117], v[116:117] op_sel:[0,0,1] op_sel_hi:[1,0,1]
  v_pk_fma_f32 v[98:99], v[98:99], v[116:117], v[116:117] op_sel:[0,0,1] op_sel_hi:[1,0,1]
  v_pk_fma_f32 v[100:101], v[100:101], v[116:117], v[116:117] op_sel:[0,0,1] op_sel_hi:[1,0,1]
  v_pk_fma_f32 v[102:103], v[102:103], v[116:117], v[116:117] op_sel:[0,0,1] op_sel_hi:[1,0,1]
  v_pk_fma_f32 v[104:105], v[104:105], v[116:117], v[116:117] op_sel:[0,0,1] op_sel_hi:[1,0,1]
  v_pk_fma_f32 v[106:107], v[106:107], v[116:117], v[116:117] op_sel:[0,0,1] op_sel_hi:[1,0,1]
  v_pk_fma_f32 v[108:109], v[108:109], v[116:117], v[116:117] op_sel:[0,0,1] op_sel_hi:[1,0,1]
  v_pk_fma_f32 v[110:111], v[110:111], v[116:117], v[116:117] op_sel:[0,0,1] op_sel_hi:[1,0,1]
  v_pk_fma_f32 v[112:113], v[112:113], v[116:117], v[116:117] op_sel:[0,0,1] op_sel_hi:[1,0,1]
  v_pk_fma_f32 v[114:115], v[114:115], v[116:117], v[116:117] op_sel:[0,0,1] op_sel_hi:[1,0,1]
  v_cvt_pk_bf16_f32 v8, v96, v97
  v_cvt_pk_bf16_f32 v9, v98, v99
  ds_write_b64 v83, v[8:9] offset:0
  v_cvt_pk_bf16_f32 v10, v100, v101
  v_cvt_pk_bf16_f32 v11, v102, v103
  ds_write_b64 v83, v[10:11] offset:256
  v_cvt_pk_bf16_f32 v12, v104, v105
  v_cvt_pk_bf16_f32 v13, v106, v107
  ds_write_b64 v83, v[12:13] offset:512
  v_cvt_pk_bf16_f32 v14, v108, v109
  v_cvt_pk_bf16_f32 v15, v110, v111
  ds_write_b64 v83, v[14:15] offset:768
  v_cvt_pk_bf16_f32 v16, v112, v113
  v_cvt_pk_bf16_f32 v17, v114, v115
  ds_write_b64 v83, v[16:17] offset:1024
  s_waitcnt lgkmcnt(0)
  ds_read_b64_tr_b16 v[96:97], v84 offset:0
  ds_read_b64_tr_b16 v[98:99], v85 offset:0
  ds_read_b64_tr_b16 v[100:101], v84 offset:32
  ds_read_b64_tr_b16 v[102:103], v85 offset:32
  ds_read_b64_tr_b16 v[104:105], v84 offset:1280
  ds_read_b64_tr_b16 v[106:107], v85 offset:1280
  ds_read_b64_tr_b16 v[108:109], v84 offset:1312
  ds_read_b64_tr_b16 v[110:111], v85 offset:1312
  s_waitcnt lgkmcnt(4)
  v_mfma_f32_16x16x32_bf16 v[120:123], v[96:99], v[20:23], 0
  v_mfma_f32_16x16x32_bf16 v[128:131], v[96:99], v[24:27], 0
  v_mfma_f32_16x16x32_bf16 v[124:127], v[100:103], v[20:23], 0
  v_mfma_f32_16x16x32_bf16 v[132:135], v[100:103], v[24:27], 0
  s_waitcnt lgkmcnt(0)
  v_mfma_f32_16x16x32_bf16 v[136:139], v[104:107], v[20:23], 0
  v_mfma_f32_16x16x32_bf16 v[144:147], v[104:107], v[24:27], 0
  v_mfma_f32_16x16x32_bf16 v[140:143], v[108:111], v[20:23], 0
  v_mfma_f32_16x16x32_bf16 v[148:151], v[108:111], v[24:27], 0
  v_pk_mul_f32 v[152:153], v[120:121], v[28:29]
  v_pk_mul_f32 v[160:161], v[128:129], v[28:29]
  v_pk_fma_f32 v[152:153], v[128:129], v[36:37], v[152:153]
  v_pk_fma_f32 v[160:161], v[120:121], v[36:37], v[160:161] neg_lo:[1,0,0] neg_hi:[1,0,0]
  v_pk_mul_f32 v[154:155], v[122:123], v[30:31]
  v_pk_mul_f32 v[162:163], v[130:131], v[30:31]
  v_pk_fma_f32 v[154:155], v[130:131], v[38:39], v[154:155]
  v_pk_fma_f32 v[162:163], v[122:123], v[38:39], v[162:163] neg_lo:[1,0,0] neg_hi:[1,0,0]
  v_pk_mul_f32 v[156:157], v[124:125], v[32:33]
  v_pk_mul_f32 v[164:165], v[132:133], v[32:33]
  v_pk_fma_f32 v[156:157], v[132:133], v[40:41], v[156:157]
  v_pk_fma_f32 v[164:165], v[124:125], v[40:41], v[164:165] neg_lo:[1,0,0] neg_hi:[1,0,0]
  v_pk_mul_f32 v[158:159], v[126:127], v[34:35]
  v_pk_mul_f32 v[166:167], v[134:135], v[34:35]
  v_pk_fma_f32 v[158:159], v[134:135], v[42:43], v[158:159]
  v_pk_fma_f32 v[166:167], v[126:127], v[42:43], v[166:167] neg_lo:[1,0,0] neg_hi:[1,0,0]
  v_cvt_pk_bf16_f32 v96, v152, v153
  v_cvt_pk_bf16_f32 v97, v154, v155
  v_cvt_pk_bf16_f32 v98, v156, v157
  v_cvt_pk_bf16_f32 v99, v158, v159
  v_cvt_pk_bf16_f32 v100, v160, v161
  v_cvt_pk_bf16_f32 v101, v162, v163
  v_cvt_pk_bf16_f32 v102, v164, v165
  v_cvt_pk_bf16_f32 v103, v166, v167
  v_mfma_f32_16x16x32_bf16 v[120:123], v[44:47], v[96:99], 0
  v_mfma_f32_16x16x32_bf16 v[124:127], v[56:59], v[96:99], 0
  v_mfma_f32_16x16x32_bf16 v[128:131], v[52:55], v[96:99], 0
  v_mfma_f32_16x16x32_bf16 v[132:135], v[60:63], v[96:99], 0
  v_mfma_f32_16x16x32_bf16 v[120:123], v[48:51], v[100:103], v[120:123]
  v_mfma_f32_16x16x32_bf16 v[124:127], v[60:63], v[100:103], v[124:127]
  v_mfma_f32_16x16x32_bf16 v[128:131], v[44:47], v[100:103], v[128:131]
  v_mfma_f32_16x16x32_bf16 v[132:135], v[64:67], v[100:103], v[132:135]
  v_pk_mul_f32 v[152:153], v[136:137], v[28:29]
  v_pk_mul_f32 v[160:161], v[144:145], v[28:29]
  v_pk_fma_f32 v[152:153], v[144:145], v[36:37], v[152:153]
  v_pk_fma_f32 v[160:161], v[136:137], v[36:37], v[160:161] neg_lo:[1,0,0] neg_hi:[1,0,0]
  v_pk_mul_f32 v[154:155], v[138:139], v[30:31]
  v_pk_mul_f32 v[162:163], v[146:147], v[30:31]
  v_pk_fma_f32 v[154:155], v[146:147], v[38:39], v[154:155]
  v_pk_fma_f32 v[162:163], v[138:139], v[38:39], v[162:163] neg_lo:[1,0,0] neg_hi:[1,0,0]
  v_pk_mul_f32 v[156:157], v[140:141], v[32:33]
  v_pk_mul_f32 v[164:165], v[148:149], v[32:33]
  v_pk_fma_f32 v[156:157], v[148:149], v[40:41], v[156:157]
  v_pk_fma_f32 v[164:165], v[140:141], v[40:41], v[164:165] neg_lo:[1,0,0] neg_hi:[1,0,0]
  v_pk_mul_f32 v[158:159], v[142:143], v[34:35]
  v_pk_mul_f32 v[166:167], v[150:151], v[34:35]
  v_pk_fma_f32 v[158:159], v[150:151], v[42:43], v[158:159]
  v_pk_fma_f32 v[166:167], v[142:143], v[42:43], v[166:167] neg_lo:[1,0,0] neg_hi:[1,0,0]
  v_cvt_pk_bf16_f32 v104, v152, v153
  v_cvt_pk_bf16_f32 v105, v154, v155
  v_cvt_pk_bf16_f32 v106, v156, v157
  v_cvt_pk_bf16_f32 v107, v158, v159
  v_cvt_pk_bf16_f32 v108, v160, v161
  v_cvt_pk_bf16_f32 v109, v162, v163
  v_cvt_pk_bf16_f32 v110, v164, v165
  v_cvt_pk_bf16_f32 v111, v166, v167
  v_mfma_f32_16x16x32_bf16 v[136:139], v[44:47], v[104:107], 0
  v_mfma_f32_16x16x32_bf16 v[140:143], v[56:59], v[104:107], 0
  v_mfma_f32_16x16x32_bf16 v[144:147], v[52:55], v[104:107], 0
  v_mfma_f32_16x16x32_bf16 v[148:151], v[60:63], v[104:107], 0
  v_mfma_f32_16x16x32_bf16 v[136:139], v[48:51], v[108:111], v[136:139]
  v_mfma_f32_16x16x32_bf16 v[140:143], v[60:63], v[108:111], v[140:143]
  v_mfma_f32_16x16x32_bf16 v[144:147], v[44:47], v[108:111], v[144:147]
  v_mfma_f32_16x16x32_bf16 v[148:151], v[64:67], v[108:111], v[148:151]
  s_nop 4
  v_cvt_pk_bf16_f32 v152, v120, v136
  v_cvt_pk_bf16_f32 v153, v121, v137
  v_cvt_pk_bf16_f32 v154, v122, v138
  v_cvt_pk_bf16_f32 v155, v123, v139
  v_cvt_pk_bf16_f32 v156, v124, v140
  v_cvt_pk_bf16_f32 v157, v125, v141
  v_cvt_pk_bf16_f32 v158, v126, v142
  v_cvt_pk_bf16_f32 v159, v127, v143
  v_cvt_pk_bf16_f32 v160, v128, v144
  v_cvt_pk_bf16_f32 v161, v129, v145
  v_cvt_pk_bf16_f32 v162, v130, v146
  v_cvt_pk_bf16_f32 v163, v131, v147
  v_cvt_pk_bf16_f32 v164, v132, v148
  v_cvt_pk_bf16_f32 v165, v133, v149
  v_cvt_pk_bf16_f32 v166, v134, v150
  v_cvt_pk_bf16_f32 v167, v135, v151
  s_mov_b32 exec_lo, 0x07ff07ff
  s_mov_b32 exec_hi, 0x07ff07ff
  ds_write_b32 v86, v152 offset:0
  ds_write_b32 v86, v153 offset:80
  ds_write_b32 v86, v154 offset:160
  ds_write_b32 v86, v155 offset:240
  ds_write_b32 v86, v160 offset:1296
  ds_write_b32 v86, v161 offset:1376
  ds_write_b32 v86, v162 offset:1456
  ds_write_b32 v86, v163 offset:1536
  s_mov_b32 exec_lo, 0x03fe03ff
  s_mov_b32 exec_hi, 0x03fe03fe
  ds_write_b32 v87, v156 offset:240
  ds_write_b32 v87, v164 offset:1536
  s_mov_b32 exec_lo, 0x03fe03fe
  s_mov_b32 exec_hi, 0x03fe03fe
  ds_write_b32 v87, v157 offset:160
  ds_write_b32 v87, v158 offset:80
  ds_write_b32 v87, v159 offset:0
  ds_write_b32 v87, v165 offset:1456
  ds_write_b32 v87, v166 offset:1376
  ds_write_b32 v87, v167 offset:1296
  s_mov_b64 exec, -1
  s_waitcnt lgkmcnt(0)
  s_barrier
  ds_read2st64_b32 v[120:121], v88 offset0:0 offset1:11
  ds_read2st64_b32 v[122:123], v88 offset0:22 offset1:33
  ds_read2st64_b32 v[124:125], v88 offset0:2 offset1:13
  ds_read2st64_b32 v[126:127], v88 offset0:24 offset1:35
  ds_read2st64_b32 v[128:129], v88 offset0:4 offset1:15
  ds_read2st64_b32 v[130:131], v88 offset0:26 offset1:37
  s_waitcnt lgkmcnt(4)
  buffer_store_dwordx4 v[120:123], v89, s[16:19], s24 offen
  s_waitcnt lgkmcnt(2)
  buffer_store_dwordx4 v[124:127], v89, s[16:19], s26 offen
  s_waitcnt lgkmcnt(0)
  buffer_store_dwordx4 v[128:131], v89, s[16:19], s27 offen
  s_endpgm
K1_side:
  s_cmp_ge_u32 s2, 448
  s_cbranch_scc1 K1_side2
  v_lshrrev_b32 v1, 6, v0
  v_and_b32 v2, 63, v0
  v_readfirstlane_b32 s25, v1
  s_sub_u32 s24, s2, 256
  s_lshl_b32 s24, s24, 2
  s_nop 1
  s_add_u32 s24, s24, s25
  s_lshr_b32 s26, s24, 7
  s_and_b32 s27, s24, 127
  s_lshl_b32 s26, s26, 6
  v_add_u32 v2, s26, v2
  v_lshlrev_b32 v3, 1, v2
  v_and_b32 v7, 63, v0
  v_lshlrev_b32 v6, 12, v1
  v_lshl_add_u32 v5, v7, 6, v6
  v_lshl_add_u32 v6, v7, 4, v6
  v_lshrrev_b32 v4, 2, v7
  v_add_u32 v4, s26, v4
  v_lshlrev_b32 v4, 13, v4
  v_and_b32 v7, 3, v0
  v_lshl_add_u32 v4, v7, 4, v4
  s_lshr_b32 s28, s27, 5
  s_lshl_b32 s28, s28, 4
  s_and_b32 s29, s27, 3
  s_lshl_b32 s29, s29, 2
  s_add_u32 s28, s28, s29
  s_lshr_b32 s29, s27, 2
  s_and_b32 s29, s29, 7
  s_lshl_b32 s29, s29, 8
  s_add_u32 s28, s28, s29
  s_mul_i32 s30, s28, 642
  s_add_u32 s31, s30, 41088
  s_add_u32 s32, s31, 41088
  s_add_u32 s33, s32, 41088
  s_lshl_b32 s34, s27, 6
  s_waitcnt lgkmcnt(0)
  s_mov_b32 s12, s8
  s_mov_b32 s13, s9
  s_mov_b32 s14, 1314816
  s_mov_b32 s15, 0x20000
  s_mov_b32 s16, s10
  s_mov_b32 s17, s11
  s_mov_b32 s18, 1314816
  s_mov_b32 s19, 0x20000
  s_add_u32 s20, s6, 4194304
  s_addc_u32 s21, s7, 0
  s_mov_b32 s22, 2629632
  s_mov_b32 s23, 0x20000
  s_cmp_lg_u32 s2, 256
  s_cbranch_scc1 K1_nofl
  s_add_u32 s36, s6, 37748736
  s_addc_u32 s37, s7, 0
  s_mov_b32 s38, 12288
  s_mov_b32 s39, 0x20000
  v_mov_b32 v8, 0
  v_mov_b32 v9, 0
  v_mov_b32 v10, 0
  v_mov_b32 v11, 0
  v_lshlrev_b32 v24, 4, v0
  buffer_store_dwordx4 v[8:11], v24, s[36:39], 0 offen
  s_mov_b32 s29, 4096
  buffer_store_dwordx4 v[8:11], v24, s[36:39], s29 offen
  s_mov_b32 s29, 8192
  buffer_store_dwordx4 v[8:11], v24, s[36:39], s29 offen
  s_waitcnt vmcnt(0)
K1_nofl:
  buffer_load_ushort v8, v3, s[12:15], s30 offen offset:0
  buffer_load_ushort v24, v3, s[16:19], s30 offen offset:0
  buffer_load_ushort v9, v3, s[12:15], s31 offen offset:0
  buffer_load_ushort v25, v3, s[16:19], s31 offen offset:0
  buffer_load_ushort v10, v3, s[12:15], s32 offen offset:0
  buffer_load_ushort v26, v3, s[16:19], s32 offen offset:0
  buffer_load_ushort v11, v3, s[12:15], s33 offen offset:0
  buffer_load_ushort v27, v3, s[16:19], s33 offen offset:0
  buffer_load_ushort v12, v3, s[12:15], s30 offen offset:642
  buffer_load_ushort v28, v3, s[16:19], s30 offen offset:642
  buffer_load_ushort v13, v3, s[12:15], s31 offen offset:642
  buffer_load_ushort v29, v3, s[16:19], s31 offen offset:642
  buffer_load_ushort v14, v3, s[12:15], s32 offen offset:642
  buffer_load_ushort v30, v3, s[16:19], s32 offen offset:642
  buffer_load_ushort v15, v3, s[12:15], s33 offen offset:642
  buffer_load_ushort v31, v3, s[16:19], s33 offen offset:642
  buffer_load_ushort v16, v3, s[12:15], s30 offen offset:1284
  buffer_load_ushort v32, v3, s[16:19], s30 offen offset:1284
  buffer_load_ushort v17, v3, s[12:15], s31 offen offset:1284
  buffer_load_ushort v33, v3, s[16:19], s31 offen offset:1284
  buffer_load_ushort v18, v3, s[12:15], s32 offen offset:1284
  buffer_load_ushort v34, v3, s[16:19], s32 offen offset:1284
  buffer_load_ushort v19, v3, s[12:15], s33 offen offset:1284
  buffer_load_ushort v35, v3, s[16:19], s33 offen offset:1284
  buffer_load_ushort v20, v3, s[12:15], s30 offen offset:1926
  buffer_load_ushort v36, v3, s[16:19], s30 offen offset:1926
  buffer_load_ushort v21, v3, s[12:15], s31 offen offset:1926
  buffer_load_ushort v37, v3, s[16:19], s31 offen offset:1926
  buffer_load_ushort v22, v3, s[12:15], s32 offen offset:1926
  buffer_load_ushort v38, v3, s[16:19], s32 offen offset:1926
  buffer_load_ushort v23, v3, s[12:15], s33 offen offset:1926
  buffer_load_ushort v39, v3, s[16:19], s33 offen offset:1926
  s_waitcnt vmcnt(24)
  v_lshl_or_b32 v8, v24, 16, v8
  v_lshl_or_b32 v9, v25, 16, v9
  v_lshl_or_b32 v10, v26, 16, v10
  v_lshl_or_b32 v11, v27, 16, v11
  ds_write_b128 v5, v[8:11] offset:0
  s_waitcnt vmcnt(16)
  v_lshl_or_b32 v12, v28, 16, v12
  v_lshl_or_b32 v13, v29, 16, v13
  v_lshl_or_b32 v14, v30, 16, v14
  v_lshl_or_b32 v15, v31, 16, v15
  ds_write_b128 v5, v[12:15] offset:16
  s_waitcnt vmcnt(8)
  v_lshl_or_b32 v16, v32, 16, v16
  v_lshl_or_b32 v17, v33, 16, v17
  v_lshl_or_b32 v18, v34, 16, v18
  v_lshl_or_b32 v19, v35, 16, v19
  ds_write_b128 v5, v[16:19] offset:32
  s_waitcnt vmcnt(0)
  v_lshl_or_b32 v20, v36, 16, v20
  v_lshl_or_b32 v21, v37, 16, v21
  v_lshl_or_b32 v22, v38, 16, v22
  v_lshl_or_b32 v23, v39, 16, v23
  ds_write_b128 v5, v[20:23] offset:48
  s_waitcnt lgkmcnt(0)
  ds_read_b128 v[8:11], v6 offset:0
  ds_read_b128 v[12:15], v6 offset:1024
  ds_read_b128 v[16:19], v6 offset:2048
  ds_read_b128 v[20:23], v6 offset:3072
  s_waitcnt lgkmcnt(3)
  buffer_store_dwordx4 v[8:11], v4, s[20:23], s34 offen
  s_add_u32 s34, s34, 131072
  s_waitcnt lgkmcnt(2)
  buffer_store_dwordx4 v[12:15], v4, s[20:23], s34 offen
  s_add_u32 s34, s34, 131072
  s_waitcnt lgkmcnt(1)
  buffer_store_dwordx4 v[16:19], v4, s[20:23], s34 offen
  s_add_u32 s34, s34, 131072
  s_waitcnt lgkmcnt(0)
  buffer_store_dwordx4 v[20:23], v4, s[20:23], s34 offen
  s_endpgm
K1_side2:
  s_cmp_ge_u32 s2, 588
  s_cbranch_scc1 K1_done
  s_load_dwordx2 s[12:13], s[0:1], 32
  v_lshrrev_b32 v1, 6, v0
  v_and_b32 v2, 63, v0
  v_readfirstlane_b32 s25, v1
  v_and_b32 v3, 15, v2
  v_lshrrev_b32 v4, 4, v2
  s_sub_u32 s24, s2, 448
  s_lshl_b32 s24, s24, 2
  s_add_u32 s24, s24, s25
  s_mul_i32 s27, s24, 2341
  s_lshr_b32 s27, s27, 16
  s_mul_i32 s28, s27, 28
  s_sub_u32 s26, s24, s28
  s_lshl_b32 s38, s26, 2
  s_mul_i32 s39, s38, 43
  s_lshr_b32 s39, s39, 8
  s_mul_i32 s39, s39, 134
  s_add_u32 s39, s39, s38
  s_mul_i32 s34, s38, 140
  s_sub_u32 s34, s34, 13434
  s_cmp_lt_u32 s38, 96
  s_cselect_b32 s34, s39, s34
  s_lshl_b32 s34, s34, 10
  s_lshl_b32 s38, s26, 2
  s_add_u32 s38, s38, 1
  s_mul_i32 s39, s38, 43
  s_lshr_b32 s39, s39, 8
  s_mul_i32 s39, s39, 134
  s_add_u32 s39, s39, s38
  s_mul_i32 s35, s38, 140
  s_sub_u32 s35, s35, 13434
  s_cmp_lt_u32 s38, 96
  s_cselect_b32 s35, s39, s35
  s_lshl_b32 s35, s35, 10
  s_lshl_b32 s38, s26, 2
  s_add_u32 s38, s38, 2
  s_mul_i32 s39, s38, 43
  s_lshr_b32 s39, s39, 8
  s_mul_i32 s39, s39, 134
  s_add_u32 s39, s39, s38
  s_mul_i32 s36, s38, 140
  s_sub_u32 s36, s36, 13434
  s_cmp_lt_u32 s38, 96
  s_cselect_b32 s36, s39, s36
  s_lshl_b32 s36, s36, 10
  s_lshl_b32 s38, s26, 2
  s_add_u32 s38, s38, 3
  s_mul_i32 s39, s38, 43
  s_lshr_b32 s39, s39, 8
  s_mul_i32 s39, s39, 134
  s_add_u32 s39, s39, s38
  s_mul_i32 s37, s38, 140
  s_sub_u32 s37, s37, 13434
  s_cmp_lt_u32 s38, 96
  s_cselect_b32 s37, s39, s37
  s_lshl_b32 s37, s37, 10
  s_mul_i32 s29, s27, 7168
  s_add_u32 s34, s34, s29
  s_add_u32 s35, s35, s29
  s_add_u32 s36, s36, s29
  s_add_u32 s37, s37, s29
  s_cmp_eq_u32 s26, 27
  s_cselect_b32 s26, 24, s26
  s_mov_b32 s32, 27648
  s_mov_b32 s33, 13824
  v_lshrrev_b32 v8, 2, v3
  v_lshlrev_b32 v9, 12, v1
  v_lshl_add_u32 v8, v8, 10, v9
  v_lshl_add_u32 v8, v4, 8, v8
  v_and_b32 v7, 3, v3
  v_lshl_add_u32 v8, v7, 6, v8
  v_lshlrev_b32 v7, 4, v2
  v_add_u32 v9, v7, v9
  v_mul_lo_u32 v5, v4, s32
  v_lshl_add_u32 v5, v3, 3, v5
  v_add_u32 v6, s33, v5
  s_mul_i32 s28, s27, 110592
  s_lshl_b32 s26, s26, 7
  s_add_u32 s28, s28, s26
  s_mov_b32 s30, 0x05040100
  s_mov_b32 s31, 0x07060302
  s_waitcnt lgkmcnt(0)
  s_mov_b32 s16, s12
  s_mov_b32 s17, s13
  s_mov_b32 s18, 2211840
  s_mov_b32 s19, 0x20000
  s_add_u32 s20, s6, 20971520
  s_addc_u32 s21, s7, 0
  s_mov_b32 s22, 2293760
  s_mov_b32 s23, 0x20000
  buffer_load_dwordx2 v[10:11], v5, s[16:19], s28 offen offset:0
  buffer_load_dwordx2 v[12:13], v5, s[16:19], s28 offen offset:3456
  v_add_u32 v46, 6912, v5
  buffer_load_dwordx2 v[14:15], v46, s[16:19], s28 offen
  v_add_u32 v47, 10368, v5
  buffer_load_dwordx2 v[16:17], v47, s[16:19], s28 offen
  buffer_load_dwordx2 v[18:19], v6, s[16:19], s28 offen offset:0
  buffer_load_dwordx2 v[20:21], v6, s[16:19], s28 offen offset:3456
  v_add_u32 v50, 6912, v6
  buffer_load_dwordx2 v[22:23], v50, s[16:19], s28 offen
  v_add_u32 v51, 10368, v6
  buffer_load_dwordx2 v[24:25], v51, s[16:19], s28 offen
  s_waitcnt vmcnt(0)
  v_perm_b32 v28, v12, v10, s30
  v_perm_b32 v29, v16, v14, s30
  v_perm_b32 v30, v20, v18, s30
  v_perm_b32 v31, v24, v22, s30
  ds_write_b128 v8, v[28:31] offset:0
  v_perm_b32 v32, v12, v10, s31
  v_perm_b32 v33, v16, v14, s31
  v_perm_b32 v34, v20, v18, s31
  v_perm_b32 v35, v24, v22, s31
  ds_write_b128 v8, v[32:35] offset:16
  v_perm_b32 v36, v13, v11, s30
  v_perm_b32 v37, v17, v15, s30
  v_perm_b32 v38, v21, v19, s30
  v_perm_b32 v39, v25, v23, s30
  ds_write_b128 v8, v[36:39] offset:32
  v_perm_b32 v40, v13, v11, s31
  v_perm_b32 v41, v17, v15, s31
  v_perm_b32 v42, v21, v19, s31
  v_perm_b32 v43, v25, v23, s31
  ds_write_b128 v8, v[40:43] offset:48
  s_waitcnt lgkmcnt(0)
  ds_read_b128 v[28:31], v9 offset:0
  ds_read_b128 v[32:35], v9 offset:1024
  ds_read_b128 v[36:39], v9 offset:2048
  ds_read_b128 v[40:43], v9 offset:3072
  s_waitcnt lgkmcnt(3)
  buffer_store_dwordx4 v[28:31], v7, s[20:23], s34 offen
  s_waitcnt lgkmcnt(2)
  buffer_store_dwordx4 v[32:35], v7, s[20:23], s35 offen
  s_waitcnt lgkmcnt(1)
  buffer_store_dwordx4 v[36:39], v7, s[20:23], s36 offen
  s_waitcnt lgkmcnt(0)
  buffer_store_dwordx4 v[40:43], v7, s[20:23], s37 offen
K1_done:
  s_endpgm

.globl k3_kernel
.p2align 8
.type k3_kernel,@function
k3_kernel:
  s_load_dwordx2 s[4:5], s[0:1], 80
  s_load_dwordx2 s[6:7], s[0:1], 0
  s_load_dwordx2 s[8:9], s[0:1], 40
  s_load_dwordx4 s[12:15], s[0:1], 56
  s_load_dwordx2 s[10:11], s[0:1], 48
  s_cmp_ge_u32 s2, 256
  s_cbranch_scc1 K3_done
  v_lshrrev_b32 v1, 6, v0
  s_and_b32 s24, s2, 1
  v_readfirstlane_b32 s21, v1
  s_lshl_b32 s24, s24, 3
  s_bfe_u32 s22, s2, 0x30003
  s_add_u32 s24, s24, s22
  s_mul_i32 s24, s24, 143360
  s_add_u32 s24, s24, 20950016
  s_mul_i32 s20, s21, 29696
  s_cmp_eq_u32 s21, 0
  s_cselect_b32 s22, 10240, 0
  s_add_u32 s21, s20, 45056
  s_sub_u32 s20, s21, s22
  s_add_u32 s22, s20, s24
  s_add_u32 s23, s21, s24
  v_lshlrev_b32 v1, 4, v0
  v_and_b32 v1, 0x3f0, v1
  s_cmp_ge_u32 s2, 161
  s_cbranch_scc1 K3_w2
  s_lshl_b32 s42, s2, 14
  s_add_u32 s43, s42, 8192
  v_and_b32 v2, 15, v0
  v_bfe_u32 v3, v0, 4, 2
  v_lshrrev_b32 v4, 6, v0
  s_nop 0
  v_readfirstlane_b32 s44, v4
  v_lshl_add_u32 v6, v4, 3, v3
  v_and_b32 v8, 15, v6
  v_xor_b32 v8, v8, v2
  v_lshlrev_b32 v8, 4, v8
  v_lshl_add_u32 v6, v6, 8, v8
  v_xor_b32 v8, 64, v6
  s_lshl_b32 s44, s44, 11
  s_add_u32 m0, s44, 18432
  v_and_b32 v5, 63, v0
  v_lshlrev_b32 v7, 4, v5
  v_lshl_add_u32 v7, v4, 11, v7
  v_cvt_f32_u32 v186, v5
  v_mul_f32 v186, 0x3c800000, v186
  v_cos_f32 v180, v186
  v_sin_f32 v181, v186
  v_lshl_add_u32 v184, v4, 4, v2
  v_lshlrev_b32 v186, 2, v184
  v_mul_u32_u24 v172, v186, v3
  v_lshlrev_b32 v172, 3, v172
  v_cvt_pk_bf16_f32 v188, v180, v181
  v_add_u32 v173, v172, v186
  v_add_u32 v174, v173, v186
  v_add_u32 v175, v174, v186
  v_add_u32 v176, v175, v186
  v_add_u32 v177, v176, v186
  v_add_u32 v178, v177, v186
  v_add_u32 v179, v178, v186
  ds_bpermute_b32 v12, v172, v188
  ds_bpermute_b32 v13, v173, v188
  ds_bpermute_b32 v14, v174, v188
  ds_bpermute_b32 v15, v175, v188
  ds_bpermute_b32 v16, v176, v188
  ds_bpermute_b32 v17, v177, v188
  ds_bpermute_b32 v18, v178, v188
  ds_bpermute_b32 v19, v179, v188
  v_lshlrev_b32 v186, 3, v2
  v_mul_u32_u24 v28, v186, v3
  v_lshlrev_b32 v28, 2, v28
  v_add_u32 v29, v28, v186
  v_add_u32 v30, v29, v186
  v_add_u32 v31, v30, v186
  ds_bpermute_b32 v20, v28, v188
  ds_bpermute_b32 v21, v29, v188
  ds_bpermute_b32 v22, v30, v188
  ds_bpermute_b32 v23, v31, v188
  s_mov_b32 s45, 0x05040100
  s_mov_b32 s46, 0x07060302
  v_cvt_f32_u32 v184, v184
  v_cvt_f32_u32 v185, v3
  v_cvt_f32_u32 v187, v2
  v_mul_f32 v185, 4.0, v185
  v_mul_f32 v186, 0x3a000000, v184
  v_mul_f32 v32, v186, v185
  v_add_f32 v33, v32, v186
  v_add_f32 v34, v186, v186
  v_mul_f32 v35, 0x41800000, v186
  v_cos_f32 v140, v32
  v_sin_f32 v148, v32
  v_cos_f32 v141, v33
  v_sin_f32 v149, v33
  v_cos_f32 v36, v34
  v_sin_f32 v37, v34
  v_cos_f32 v38, v35
  v_sin_f32 v39, v35
  v_pk_mul_f32 v[142:143], v[140:141], v[36:37] op_sel_hi:[1,0]
  v_pk_mul_f32 v[150:151], v[148:149], v[36:37] op_sel_hi:[1,0]
  v_pk_fma_f32 v[142:143], v[148:149], v[36:37], v[142:143] op_sel:[0,1,0] neg_lo:[1,0,0] neg_hi:[1,0,0]
  v_pk_fma_f32 v[150:151], v[140:141], v[36:37], v[150:151] op_sel:[0,1,0]
  v_pk_mul_f32 v[144:145], v[140:141], v[38:39] op_sel_hi:[1,0]
  v_pk_mul_f32 v[152:153], v[148:149], v[38:39] op_sel_hi:[1,0]
  v_pk_fma_f32 v[144:145], v[148:149], v[38:39], v[144:145] op_sel:[0,1,0] neg_lo:[1,0,0] neg_hi:[1,0,0]
  s_waitcnt lgkmcnt(0)
  s_mov_b32 s28, s4
  s_mov_b32 s29, s5
  s_mov_b32 s30, 2629632
  s_mov_b32 s31, 0x20000
  s_add_u32 s32, s4, 4194304
  s_addc_u32 s33, s5, 0
  s_mov_b32 s34, 2629632
  s_mov_b32 s35, 0x20000
  buffer_load_dwordx4 v6, s[28:31], s42 offen lds
  buffer_load_dwordx4 v8, s[28:31], s42 offen offset:1024 lds
  s_add_u32 m0, s44, 26624
  s_nop 0
  buffer_load_dwordx4 v6, s[28:31], s43 offen lds
  buffer_load_dwordx4 v8, s[28:31], s43 offen offset:1024 lds
  s_mov_b32 s16, s4
  s_mov_b32 s17, s5
  s_mov_b32 s18, 41943040
  s_mov_b32 s19, 0x20000
  s_add_u32 s36, s4, 8388608
  s_addc_u32 s37, s5, 0
  s_mov_b32 s38, 2654208
  s_mov_b32 s39, 0x20000
  v_pk_fma_f32 v[152:153], v[140:141], v[38:39], v[152:153] op_sel:[0,1,0]
  v_pk_mul_f32 v[146:147], v[142:143], v[38:39] op_sel_hi:[1,0]
  v_pk_mul_f32 v[154:155], v[150:151], v[38:39] op_sel_hi:[1,0]
  v_pk_fma_f32 v[146:147], v[150:151], v[38:39], v[146:147] op_sel:[0,1,0] neg_lo:[1,0,0] neg_hi:[1,0,0]
  v_pk_fma_f32 v[154:155], v[142:143], v[38:39], v[154:155] op_sel:[0,1,0]
  s_waitcnt lgkmcnt(0)
  v_and_b32 v188, 1, v0
  v_mul_u32_u24 v188, 0x8000, v188
  v_lshl_or_b32 v188, v188, 16, v188
  v_perm_b32 v92, v13, v12, s45
  v_perm_b32 v100, v13, v12, s46
  v_perm_b32 v93, v15, v14, s45
  v_perm_b32 v101, v15, v14, s46
  v_perm_b32 v94, v17, v16, s45
  v_perm_b32 v102, v17, v16, s46
  v_perm_b32 v95, v19, v18, s45
  v_perm_b32 v103, v19, v18, s46
  v_xor_b32 v96, v188, v92
  v_xor_b32 v104, v188, v100
  v_xor_b32 v108, 0x80008000, v100
  v_xor_b32 v112, 0x80008000, v104
  v_xor_b32 v97, v188, v93
  v_xor_b32 v105, v188, v101
  v_xor_b32 v109, 0x80008000, v101
  v_xor_b32 v113, 0x80008000, v105
  v_xor_b32 v98, v188, v94
  v_xor_b32 v106, v188, v102
  v_xor_b32 v110, 0x80008000, v102
  v_xor_b32 v114, 0x80008000, v106
  v_xor_b32 v99, v188, v95
  v_xor_b32 v107, v188, v103
  v_xor_b32 v111, 0x80008000, v103
  v_xor_b32 v115, 0x80008000, v107
  v_perm_b32 v116, v21, v20, s45
  v_perm_b32 v124, v21, v20, s46
  v_perm_b32 v117, v23, v22, s45
  v_perm_b32 v125, v23, v22, s46
  v_xor_b32 v118, v188, v116
  v_xor_b32 v126, v188, v124
  v_xor_b32 v119, v188, v117
  v_xor_b32 v127, v188, v125
  v_xor_b32 v120, 0x80000000, v116
  v_xor_b32 v128, 0x80000000, v124
  v_xor_b32 v132, 0x80008000, v124
  v_xor_b32 v136, 0x00008000, v124
  v_xor_b32 v121, 0x80000000, v117
  v_xor_b32 v129, 0x80000000, v125
  v_xor_b32 v133, 0x80008000, v125
  v_xor_b32 v137, 0x00008000, v125
  v_xor_b32 v122, 0x80000000, v118
  v_xor_b32 v130, 0x80000000, v126
  v_xor_b32 v134, 0x80008000, v126
  v_xor_b32 v138, 0x00008000, v126
  v_xor_b32 v123, 0x80000000, v119
  v_xor_b32 v131, 0x80000000, v127
  v_xor_b32 v135, 0x80008000, v127
  v_xor_b32 v139, 0x00008000, v127
  v_cvt_f32_u32 v180, v4
  v_fmamk_f32 v180, v180, 0x41800000, v185
  v_mul_f32 v186, 0x3a000000, v187
  buffer_load_dwordx4 v[76:79], v7, s[32:35], s42 offen offset:0
  buffer_load_dwordx4 v[80:83], v7, s[32:35], s42 offen offset:1024
  buffer_load_dwordx4 v[84:87], v7, s[32:35], s43 offen offset:0
  buffer_load_dwordx4 v[88:91], v7, s[32:35], s43 offen offset:1024
  s_add_u32 m0, s20, 0
  s_add_u32 s24, s22, 0
  buffer_load_dwordx4 v1, s[16:19], s24 offen offset:0 lds
  v_mul_f32 v32, v186, v180
  v_add_f32 v33, v32, v186
  v_add_f32 v34, v186, v186
  v_cos_f32 v156, v32
  v_sin_f32 v164, v32
  v_cos_f32 v157, v33
  v_sin_f32 v165, v33
  v_cos_f32 v36, v34
  v_sin_f32 v37, v34
  v_mul_f32 v156, 0x35cccccd, v156
  v_mul_f32 v164, 0x35cccccd, v164
  v_mul_f32 v157, 0x35cccccd, v157
  v_mul_f32 v165, 0x35cccccd, v165
  buffer_load_dwordx4 v1, s[16:19], s24 offen offset:1024 lds
  v_pk_mul_f32 v[158:159], v[156:157], v[36:37] op_sel_hi:[1,0]
  v_pk_mul_f32 v[166:167], v[164:165], v[36:37] op_sel_hi:[1,0]
  v_pk_fma_f32 v[158:159], v[164:165], v[36:37], v[158:159] op_sel:[0,1,0] neg_lo:[1,0,0] neg_hi:[1,0,0]
  v_pk_fma_f32 v[166:167], v[156:157], v[36:37], v[166:167] op_sel:[0,1,0]
  v_add_f32 v186, 0x3c000000, v186
  v_mul_f32 v32, v186, v180
  v_add_f32 v33, v32, v186
  v_add_f32 v34, v186, v186
  v_cos_f32 v160, v32
  v_sin_f32 v168, v32
  v_cos_f32 v161, v33
  v_sin_f32 v169, v33
  v_cos_f32 v36, v34
  v_sin_f32 v37, v34
  buffer_load_dwordx4 v1, s[16:19], s24 offen offset:2048 lds
  v_mul_f32 v160, 0x35cccccd, v160
  v_mul_f32 v168, 0x35cccccd, v168
  v_mul_f32 v161, 0x35cccccd, v161
  v_mul_f32 v169, 0x35cccccd, v169
  v_pk_mul_f32 v[162:163], v[160:161], v[36:37] op_sel_hi:[1,0]
  v_pk_mul_f32 v[170:171], v[168:169], v[36:37] op_sel_hi:[1,0]
  v_pk_fma_f32 v[162:163], v[168:169], v[36:37], v[162:163] op_sel:[0,1,0] neg_lo:[1,0,0] neg_hi:[1,0,0]
  v_pk_fma_f32 v[170:171], v[160:161], v[36:37], v[170:171] op_sel:[0,1,0]
  v_mul_u32_u24 v190, 144, v2
  v_lshl_add_u32 v189, v3, 3, v190
  v_lshl_add_u32 v189, v4, 5, v189
  v_lshl_add_u32 v190, v3, 4, v190
  v_and_b32 v191, 8, v0
  buffer_load_dwordx4 v1, s[16:19], s24 offen offset:3072 lds
  v_lshl_add_u32 v191, v4, 4, v191
  v_lshl_add_u32 v191, v191, 1, v3
  v_mul_u32_u24 v191, 20736, v191
  v_and_b32 v180, 7, v0
  v_lshl_add_u32 v191, v180, 4, v191
  s_lshl_b32 s40, s2, 7
  v_lshlrev_b32 v180, 1, v3
  v_xor_b32 v180, v180, v2
  v_lshlrev_b32 v180, 4, v180
  v_lshl_add_u32 v192, v2, 8, v180
  v_xor_b32 v193, 16, v192
  v_xor_b32 v194, 128, v192
  v_xor_b32 v195, 144, v192
  s_waitcnt vmcnt(8)
  s_barrier
  s_add_u32 m0, s20, 4096
  s_add_u32 s24, s22, 4096
  buffer_load_dwordx4 v1, s[16:19], s24 offen offset:0 lds
  ds_read_b128 v[12:15], v192 offset:18432
  ds_read_b128 v[28:31], v193 offset:18432
  ds_read_b128 v[16:19], v194 offset:18432
  ds_read_b128 v[32:35], v195 offset:18432
  ds_read_b128 v[20:23], v192 offset:22528
  ds_read_b128 v[36:39], v193 offset:22528
  ds_read_b128 v[24:27], v194 offset:22528
  ds_read_b128 v[40:43], v195 offset:22528
  ds_read_b128 v[44:47], v192 offset:26624
  ds_read_b128 v[60:63], v193 offset:26624
  ds_read_b128 v[48:51], v194 offset:26624
  ds_read_b128 v[64:67], v195 offset:26624
  ds_read_b128 v[52:55], v192 offset:30720
  ds_read_b128 v[68:71], v193 offset:30720
  ds_read_b128 v[56:59], v194 offset:30720
  ds_read_b128 v[72:75], v195 offset:30720
  s_waitcnt lgkmcnt(14)
  v_mfma_f32_16x16x32_bf16 v[196:199], v[12:15], v[92:95], 0
  v_mfma_f32_16x16x32_bf16 v[204:207], v[12:15], v[108:111], 0
  v_mfma_f32_16x16x32_bf16 v[196:199], v[28:31], v[100:103], v[196:199]
  v_mfma_f32_16x16x32_bf16 v[204:207], v[28:31], v[92:95], v[204:207]
  s_waitcnt lgkmcnt(12)
  v_mfma_f32_16x16x32_bf16 v[196:199], v[16:19], v[96:99], v[196:199]
  v_mfma_f32_16x16x32_bf16 v[204:207], v[16:19], v[112:115], v[204:207]
  v_mfma_f32_16x16x32_bf16 v[196:199], v[32:35], v[104:107], v[196:199]
  v_mfma_f32_16x16x32_bf16 v[204:207], v[32:35], v[96:99], v[204:207]
  s_waitcnt lgkmcnt(10)
  v_mfma_f32_16x16x32_bf16 v[200:203], v[20:23], v[92:95], 0
  v_mfma_f32_16x16x32_bf16 v[208:211], v[20:23], v[108:111], 0
  v_mfma_f32_16x16x32_bf16 v[200:203], v[36:39], v[100:103], v[200:203]
  v_mfma_f32_16x16x32_bf16 v[208:211], v[36:39], v[92:95], v[208:211]
  s_waitcnt lgkmcnt(8)
  v_mfma_f32_16x16x32_bf16 v[200:203], v[24:27], v[96:99], v[200:203]
  v_mfma_f32_16x16x32_bf16 v[208:211], v[24:27], v[112:115], v[208:211]
  v_mfma_f32_16x16x32_bf16 v[200:203], v[40:43], v[104:107], v[200:203]
  v_mfma_f32_16x16x32_bf16 v[208:211], v[40:43], v[96:99], v[208:211]
  s_waitcnt lgkmcnt(6)
  v_mfma_f32_16x16x32_bf16 v[212:215], v[44:47], v[92:95], 0
  v_mfma_f32_16x16x32_bf16 v[220:223], v[44:47], v[108:111], 0
  v_mfma_f32_16x16x32_bf16 v[212:215], v[60:63], v[100:103], v[212:215]
  v_pk_mul_f32 v[28:29], v[196:197], v[140:141]
  v_pk_mul_f32 v[36:37], v[204:205], v[140:141]
  v_pk_fma_f32 v[28:29], v[204:205], v[148:149], v[28:29]
  v_pk_fma_f32 v[36:37], v[196:197], v[148:149], v[36:37] neg_lo:[1,0,0] neg_hi:[1,0,0]
  buffer_load_dwordx4 v1, s[16:19], s24 offen offset:1024 lds
  v_pk_mul_f32 v[30:31], v[198:199], v[142:143]
  v_mfma_f32_16x16x32_bf16 v[220:223], v[60:63], v[92:95], v[220:223]
  v_pk_mul_f32 v[38:39], v[206:207], v[142:143]
  v_pk_fma_f32 v[30:31], v[206:207], v[150:151], v[30:31]
  v_pk_fma_f32 v[38:39], v[198:199], v[150:151], v[38:39] neg_lo:[1,0,0] neg_hi:[1,0,0]
  v_pk_mul_f32 v[32:33], v[200:201], v[144:145]
  s_waitcnt lgkmcnt(4)
  v_mfma_f32_16x16x32_bf16 v[212:215], v[48:51], v[96:99], v[212:215]
  v_pk_mul_f32 v[40:41], v[208:209], v[144:145]
  v_pk_fma_f32 v[32:33], v[208:209], v[152:153], v[32:33]
  v_pk_fma_f32 v[40:41], v[200:201], v[152:153], v[40:41] neg_lo:[1,0,0] neg_hi:[1,0,0]
  v_pk_mul_f32 v[34:35], v[202:203], v[146:147]
  v_mfma_f32_16x16x32_bf16 v[220:223], v[48:51], v[112:115], v[220:223]
  v_pk_mul_f32 v[42:43], v[210:211], v[146:147]
  v_pk_fma_f32 v[34:35], v[210:211], v[154:155], v[34:35]
  v_pk_fma_f32 v[42:43], v[202:203], v[154:155], v[42:43] neg_lo:[1,0,0] neg_hi:[1,0,0]
  v_cvt_pk_bf16_f32 v172, v28, v29
  v_mfma_f32_16x16x32_bf16 v[212:215], v[64:67], v[104:107], v[212:215]
  v_cvt_pk_bf16_f32 v173, v30, v31
  v_cvt_pk_bf16_f32 v174, v32, v33
  v_cvt_pk_bf16_f32 v175, v34, v35
  v_cvt_pk_bf16_f32 v176, v36, v37
  v_mfma_f32_16x16x32_bf16 v[220:223], v[64:67], v[96:99], v[220:223]
  v_cvt_pk_bf16_f32 v177, v38, v39
  v_cvt_pk_bf16_f32 v178, v40, v41
  v_cvt_pk_bf16_f32 v179, v42, v43
  s_waitcnt vmcnt(6)
  s_waitcnt lgkmcnt(2)
  v_mfma_f32_16x16x32_bf16 v[216:219], v[52:55], v[92:95], 0
  v_lshlrev_b32 v236, 16, v76
  v_and_b32 v244, 0xffff0000, v76
  v_lshlrev_b32 v237, 16, v77
  v_and_b32 v245, 0xffff0000, v77
  v_mfma_f32_16x16x32_bf16 v[224:227], v[52:55], v[108:111], 0
  v_lshlrev_b32 v238, 16, v78
  v_and_b32 v246, 0xffff0000, v78
  v_lshlrev_b32 v239, 16, v79
  v_and_b32 v247, 0xffff0000, v79
  v_mfma_f32_16x16x32_bf16 v[216:219], v[68:71], v[100:103], v[216:219]
  v_lshlrev_b32 v240, 16, v80
  v_and_b32 v248, 0xffff0000, v80
  v_lshlrev_b32 v241, 16, v81
  v_and_b32 v249, 0xffff0000, v81
  v_mfma_f32_16x16x32_bf16 v[224:227], v[68:71], v[92:95], v[224:227]
  buffer_load_dwordx4 v1, s[16:19], s24 offen offset:2048 lds
  v_lshlrev_b32 v242, 16, v82
  v_and_b32 v250, 0xffff0000, v82
  v_lshlrev_b32 v243, 16, v83
  v_and_b32 v251, 0xffff0000, v83
  s_waitcnt lgkmcnt(0)
  v_mfma_f32_16x16x32_bf16 v[216:219], v[56:59], v[96:99], v[216:219]
  v_lshlrev_b32 v12, 16, v84
  v_and_b32 v20, 0xffff0000, v84
  v_lshlrev_b32 v13, 16, v85
  v_and_b32 v21, 0xffff0000, v85
  v_mfma_f32_16x16x32_bf16 v[224:227], v[56:59], v[112:115], v[224:227]
  v_lshlrev_b32 v14, 16, v86
  v_and_b32 v22, 0xffff0000, v86
  v_lshlrev_b32 v15, 16, v87
  v_and_b32 v23, 0xffff0000, v87
  v_mfma_f32_16x16x32_bf16 v[216:219], v[72:75], v[104:107], v[216:219]
  v_lshlrev_b32 v16, 16, v88
  v_and_b32 v24, 0xffff0000, v88
  v_lshlrev_b32 v17, 16, v89
  v_and_b32 v25, 0xffff0000, v89
  v_mfma_f32_16x16x32_bf16 v[224:227], v[72:75], v[96:99], v[224:227]
  v_lshlrev_b32 v18, 16, v90
  v_and_b32 v26, 0xffff0000, v90
  v_lshlrev_b32 v19, 16, v91
  v_and_b32 v27, 0xffff0000, v91
  s_cmp_eq_u32 s2, 0
  s_cbranch_scc1 K3_half
  s_cmp_lg_u32 s2, 160
  s_cbranch_scc1 K3_nohalf
K3_half:
  v_mul_f32 v236, 0.5, v236
  v_mul_f32 v237, 0.5, v237
  v_mul_f32 v238, 0.5, v238
  v_mul_f32 v239, 0.5, v239
  v_mul_f32 v240, 0.5, v240
  v_mul_f32 v241, 0.5, v241
  v_mul_f32 v242, 0.5, v242
  v_mul_f32 v243, 0.5, v243
  v_mul_f32 v244, 0.5, v244
  v_mul_f32 v245, 0.5, v245
  v_mul_f32 v246, 0.5, v246
  v_mul_f32 v247, 0.5, v247
  v_mul_f32 v248, 0.5, v248
  v_mul_f32 v249, 0.5, v249
  v_mul_f32 v250, 0.5, v250
  v_mul_f32 v251, 0.5, v251
K3_nohalf:
  v_mfma_f32_16x16x32_bf16 v[196:199], v[116:119], v[172:175], 0
  v_mfma_f32_16x16x32_bf16 v[204:207], v[132:135], v[172:175], 0
  v_mfma_f32_16x16x32_bf16 v[200:203], v[120:123], v[172:175], 0
  v_pk_mul_f32 v[60:61], v[212:213], v[140:141]
  v_pk_mul_f32 v[68:69], v[220:221], v[140:141]
  v_pk_fma_f32 v[60:61], v[220:221], v[148:149], v[60:61]
  v_pk_fma_f32 v[68:69], v[212:213], v[148:149], v[68:69] neg_lo:[1,0,0] neg_hi:[1,0,0]
  v_mfma_f32_16x16x32_bf16 v[208:211], v[136:139], v[172:175], 0
  v_pk_mul_f32 v[62:63], v[214:215], v[142:143]
  v_pk_mul_f32 v[70:71], v[222:223], v[142:143]
  v_pk_fma_f32 v[62:63], v[222:223], v[150:151], v[62:63]
  v_pk_fma_f32 v[70:71], v[214:215], v[150:151], v[70:71] neg_lo:[1,0,0] neg_hi:[1,0,0]
  v_mfma_f32_16x16x32_bf16 v[196:199], v[124:127], v[176:179], v[196:199]
  v_pk_mul_f32 v[64:65], v[216:217], v[144:145]
  v_pk_mul_f32 v[72:73], v[224:225], v[144:145]
  v_pk_fma_f32 v[64:65], v[224:225], v[152:153], v[64:65]
  v_pk_fma_f32 v[72:73], v[216:217], v[152:153], v[72:73] neg_lo:[1,0,0] neg_hi:[1,0,0]
  buffer_load_dwordx4 v1, s[16:19], s24 offen offset:3072 lds
  v_mfma_f32_16x16x32_bf16 v[204:207], v[116:119], v[176:179], v[204:207]
  v_pk_mul_f32 v[66:67], v[218:219], v[146:147]
  v_pk_mul_f32 v[74:75], v[226:227], v[146:147]
  v_pk_fma_f32 v[66:67], v[226:227], v[154:155], v[66:67]
  v_pk_fma_f32 v[74:75], v[218:219], v[154:155], v[74:75] neg_lo:[1,0,0] neg_hi:[1,0,0]
  v_mfma_f32_16x16x32_bf16 v[200:203], v[128:131], v[176:179], v[200:203]
  v_cvt_pk_bf16_f32 v228, v60, v61
  v_cvt_pk_bf16_f32 v229, v62, v63
  v_cvt_pk_bf16_f32 v230, v64, v65
  v_cvt_pk_bf16_f32 v231, v66, v67
  v_mfma_f32_16x16x32_bf16 v[208:211], v[120:123], v[176:179], v[208:211]
  v_cvt_pk_bf16_f32 v232, v68, v69
  v_cvt_pk_bf16_f32 v233, v70, v71
  v_cvt_pk_bf16_f32 v234, v72, v73
  v_cvt_pk_bf16_f32 v235, v74, v75
  v_mfma_f32_16x16x32_bf16 v[212:215], v[116:119], v[228:231], 0
  v_mfma_f32_16x16x32_bf16 v[220:223], v[132:135], v[228:231], 0
  v_mfma_f32_16x16x32_bf16 v[216:219], v[120:123], v[228:231], 0
  v_pk_mul_f32 v[28:29], v[196:197], v[236:237]
  v_pk_mul_f32 v[36:37], v[204:205], v[236:237]
  v_pk_fma_f32 v[28:29], v[204:205], v[244:245], v[28:29] neg_lo:[1,0,0] neg_hi:[1,0,0]
  v_pk_fma_f32 v[36:37], v[196:197], v[244:245], v[36:37]
  v_mfma_f32_16x16x32_bf16 v[224:227], v[136:139], v[228:231], 0
  v_pk_mul_f32 v[30:31], v[198:199], v[238:239]
  v_pk_mul_f32 v[38:39], v[206:207], v[238:239]
  v_pk_fma_f32 v[30:31], v[206:207], v[246:247], v[30:31] neg_lo:[1,0,0] neg_hi:[1,0,0]
  v_pk_fma_f32 v[38:39], v[198:199], v[246:247], v[38:39]
  v_mfma_f32_16x16x32_bf16 v[212:215], v[124:127], v[232:235], v[212:215]
  v_pk_mul_f32 v[32:33], v[200:201], v[240:241]
  v_pk_mul_f32 v[40:41], v[208:209], v[240:241]
  v_pk_fma_f32 v[32:33], v[208:209], v[248:249], v[32:33] neg_lo:[1,0,0] neg_hi:[1,0,0]
  v_pk_fma_f32 v[40:41], v[200:201], v[248:249], v[40:41]
  v_mfma_f32_16x16x32_bf16 v[220:223], v[116:119], v[232:235], v[220:223]
  v_pk_mul_f32 v[34:35], v[202:203], v[242:243]
  v_pk_mul_f32 v[42:43], v[210:211], v[242:243]
  v_pk_fma_f32 v[34:35], v[210:211], v[250:251], v[34:35] neg_lo:[1,0,0] neg_hi:[1,0,0]
  v_pk_fma_f32 v[42:43], v[202:203], v[250:251], v[42:43]
  v_mfma_f32_16x16x32_bf16 v[216:219], v[128:131], v[232:235], v[216:219]
  v_cvt_pk_bf16_f32 v172, v28, v29
  v_cvt_pk_bf16_f32 v173, v30, v31
  v_cvt_pk_bf16_f32 v174, v32, v33
  v_cvt_pk_bf16_f32 v175, v34, v35
  v_mfma_f32_16x16x32_bf16 v[224:227], v[120:123], v[232:235], v[224:227]
  v_cvt_pk_bf16_f32 v176, v36, v37
  s_add_u32 m0, s20, 8192
  s_add_u32 s24, s22, 8192
  buffer_load_dwordx4 v1, s[16:19], s24 offen offset:0 lds
  v_cvt_pk_bf16_f32 v177, v38, v39
  v_cvt_pk_bf16_f32 v178, v40, v41
  v_cvt_pk_bf16_f32 v179, v42, v43
  v_mfma_f32_16x16x32_bf16 v[196:199], v[172:175], v[116:119], 0
  v_mfma_f32_16x16x32_bf16 v[204:207], v[172:175], v[124:127], 0
  v_mfma_f32_16x16x32_bf16 v[200:203], v[172:175], v[120:123], 0
  v_pk_mul_f32 v[60:61], v[212:213], v[12:13]
  v_pk_mul_f32 v[68:69], v[220:221], v[12:13]
  v_pk_fma_f32 v[60:61], v[220:221], v[20:21], v[60:61] neg_lo:[1,0,0] neg_hi:[1,0,0]
  v_pk_fma_f32 v[68:69], v[212:213], v[20:21], v[68:69]
  v_mfma_f32_16x16x32_bf16 v[208:211], v[172:175], v[128:131], 0
  v_pk_mul_f32 v[62:63], v[214:215], v[14:15]
  v_pk_mul_f32 v[70:71], v[222:223], v[14:15]
  v_pk_fma_f32 v[62:63], v[222:223], v[22:23], v[62:63] neg_lo:[1,0,0] neg_hi:[1,0,0]
  v_pk_fma_f32 v[70:71], v[214:215], v[22:23], v[70:71]
  v_mfma_f32_16x16x32_bf16 v[196:199], v[176:179], v[132:135], v[196:199]
  v_pk_mul_f32 v[64:65], v[216:217], v[16:17]
  v_pk_mul_f32 v[72:73], v[224:225], v[16:17]
  v_pk_fma_f32 v[64:65], v[224:225], v[24:25], v[64:65] neg_lo:[1,0,0] neg_hi:[1,0,0]
  v_pk_fma_f32 v[72:73], v[216:217], v[24:25], v[72:73]
  v_mfma_f32_16x16x32_bf16 v[204:207], v[176:179], v[116:119], v[204:207]
  v_pk_mul_f32 v[66:67], v[218:219], v[18:19]
  v_pk_mul_f32 v[74:75], v[226:227], v[18:19]
  v_pk_fma_f32 v[66:67], v[226:227], v[26:27], v[66:67] neg_lo:[1,0,0] neg_hi:[1,0,0]
  v_pk_fma_f32 v[74:75], v[218:219], v[26:27], v[74:75]
  v_mfma_f32_16x16x32_bf16 v[200:203], v[176:179], v[136:139], v[200:203]
  v_cvt_pk_bf16_f32 v228, v60, v61
  v_cvt_pk_bf16_f32 v229, v62, v63
  v_cvt_pk_bf16_f32 v230, v64, v65
  v_cvt_pk_bf16_f32 v231, v66, v67
  v_mfma_f32_16x16x32_bf16 v[208:211], v[176:179], v[120:123], v[208:211]
  v_cvt_pk_bf16_f32 v232, v68, v69
  v_cvt_pk_bf16_f32 v233, v70, v71
  v_cvt_pk_bf16_f32 v234, v72, v73
  v_cvt_pk_bf16_f32 v235, v74, v75
  v_mfma_f32_16x16x32_bf16 v[212:215], v[228:231], v[116:119], 0
  v_mfma_f32_16x16x32_bf16 v[220:223], v[228:231], v[124:127], 0
  v_mfma_f32_16x16x32_bf16 v[216:219], v[228:231], v[120:123], 0
  v_pk_mul_f32 v[28:29], v[196:197], v[156:157]
  v_pk_mul_f32 v[36:37], v[204:205], v[156:157]
  v_pk_fma_f32 v[28:29], v[204:205], v[164:165], v[28:29] neg_lo:[1,0,0] neg_hi:[1,0,0]
  v_pk_fma_f32 v[36:37], v[196:197], v[164:165], v[36:37]
  v_pk_mul_f32 v[30:31], v[198:199], v[158:159]
  v_mfma_f32_16x16x32_bf16 v[224:227], v[228:231], v[128:131], 0
  buffer_load_dwordx4 v1, s[16:19], s24 offen offset:1024 lds
  v_pk_mul_f32 v[38:39], v[206:207], v[158:159]
  v_pk_fma_f32 v[30:31], v[206:207], v[166:167], v[30:31] neg_lo:[1,0,0] neg_hi:[1,0,0]
  v_pk_fma_f32 v[38:39], v[198:199], v[166:167], v[38:39]
  v_pk_mul_f32 v[32:33], v[200:201], v[160:161]
  v_pk_mul_f32 v[40:41], v[208:209], v[160:161]
  v_mfma_f32_16x16x32_bf16 v[212:215], v[232:235], v[132:135], v[212:215]
  v_pk_fma_f32 v[32:33], v[208:209], v[168:169], v[32:33] neg_lo:[1,0,0] neg_hi:[1,0,0]
  v_pk_fma_f32 v[40:41], v[200:201], v[168:169], v[40:41]
  v_pk_mul_f32 v[34:35], v[202:203], v[162:163]
  v_pk_mul_f32 v[42:43], v[210:211], v[162:163]
  v_mfma_f32_16x16x32_bf16 v[220:223], v[232:235], v[116:119], v[220:223]
  v_pk_fma_f32 v[34:35], v[210:211], v[170:171], v[34:35] neg_lo:[1,0,0] neg_hi:[1,0,0]
  v_pk_fma_f32 v[42:43], v[202:203], v[170:171], v[42:43]
  v_cvt_pk_bf16_f32 v172, v28, v29
  v_cvt_pk_bf16_f32 v173, v30, v31
  v_cvt_pk_bf16_f32 v174, v32, v33
  v_mfma_f32_16x16x32_bf16 v[216:219], v[232:235], v[136:139], v[216:219]
  v_cvt_pk_bf16_f32 v175, v34, v35
  v_cvt_pk_bf16_f32 v176, v36, v37
  v_cvt_pk_bf16_f32 v177, v38, v39
  v_cvt_pk_bf16_f32 v178, v40, v41
  v_cvt_pk_bf16_f32 v179, v42, v43
  v_mfma_f32_16x16x32_bf16 v[224:227], v[232:235], v[120:123], v[224:227]
  ds_write_b64 v189, v[172:173] offset:0
  ds_write_b64 v189, v[174:175] offset:2304
  ds_write_b64 v189, v[176:177] offset:4608
  ds_write_b64 v189, v[178:179] offset:6912
  v_pk_mul_f32 v[60:61], v[212:213], v[156:157]
  v_pk_mul_f32 v[68:69], v[220:221], v[156:157]
  v_pk_fma_f32 v[60:61], v[220:221], v[164:165], v[60:61] neg_lo:[1,0,0] neg_hi:[1,0,0]
  v_pk_fma_f32 v[68:69], v[212:213], v[164:165], v[68:69]
  v_pk_mul_f32 v[62:63], v[214:215], v[158:159]
  v_pk_mul_f32 v[70:71], v[222:223], v[158:159]
  v_pk_fma_f32 v[62:63], v[222:223], v[166:167], v[62:63] neg_lo:[1,0,0] neg_hi:[1,0,0]
  v_pk_fma_f32 v[70:71], v[214:215], v[166:167], v[70:71]
  v_pk_mul_f32 v[64:65], v[216:217], v[160:161]
  v_pk_mul_f32 v[72:73], v[224:225], v[160:161]
  v_pk_fma_f32 v[64:65], v[224:225], v[168:169], v[64:65] neg_lo:[1,0,0] neg_hi:[1,0,0]
  v_pk_fma_f32 v[72:73], v[216:217], v[168:169], v[72:73]
  v_pk_mul_f32 v[66:67], v[218:219], v[162:163]
  v_pk_mul_f32 v[74:75], v[226:227], v[162:163]
  v_pk_fma_f32 v[66:67], v[226:227], v[170:171], v[66:67] neg_lo:[1,0,0] neg_hi:[1,0,0]
  v_pk_fma_f32 v[74:75], v[218:219], v[170:171], v[74:75]
  v_cvt_pk_bf16_f32 v228, v60, v61
  buffer_load_dwordx4 v1, s[16:19], s24 offen offset:2048 lds
  v_cvt_pk_bf16_f32 v229, v62, v63
  v_cvt_pk_bf16_f32 v230, v64, v65
  v_cvt_pk_bf16_f32 v231, v66, v67
  v_cvt_pk_bf16_f32 v232, v68, v69
  v_cvt_pk_bf16_f32 v233, v70, v71
  v_cvt_pk_bf16_f32 v234, v72, v73
  v_cvt_pk_bf16_f32 v235, v74, v75
  ds_write_b64 v189, v[228:229] offset:9216
  ds_write_b64 v189, v[230:231] offset:11520
  ds_write_b64 v189, v[232:233] offset:13824
  ds_write_b64 v189, v[234:235] offset:16128
  s_waitcnt lgkmcnt(0)
  s_barrier
  ds_read_b128 v[12:15], v190 offset:0
  ds_read_b128 v[28:31], v190 offset:4608
  ds_read_b128 v[16:19], v190 offset:64
  ds_read_b128 v[32:35], v190 offset:4672
  ds_read_b128 v[20:23], v190 offset:2304
  ds_read_b128 v[36:39], v190 offset:6912
  ds_read_b128 v[24:27], v190 offset:2368
  ds_read_b128 v[40:43], v190 offset:6976
  ds_read_b128 v[44:47], v190 offset:9216
  ds_read_b128 v[60:63], v190 offset:13824
  ds_read_b128 v[48:51], v190 offset:9280
  ds_read_b128 v[64:67], v190 offset:13888
  ds_read_b128 v[52:55], v190 offset:11520
  ds_read_b128 v[68:71], v190 offset:16128
  ds_read_b128 v[56:59], v190 offset:11584
  ds_read_b128 v[72:75], v190 offset:16192
  s_waitcnt lgkmcnt(14)
  v_mfma_f32_16x16x32_bf16 v[196:199], v[12:15], v[92:95], 0
  v_mfma_f32_16x16x32_bf16 v[204:207], v[12:15], v[100:103], 0
  v_mfma_f32_16x16x32_bf16 v[196:199], v[28:31], v[108:111], v[196:199]
  v_mfma_f32_16x16x32_bf16 v[204:207], v[28:31], v[92:95], v[204:207]
  s_waitcnt lgkmcnt(12)
  v_mfma_f32_16x16x32_bf16 v[196:199], v[16:19], v[96:99], v[196:199]
  v_mfma_f32_16x16x32_bf16 v[204:207], v[16:19], v[104:107], v[204:207]
  v_mfma_f32_16x16x32_bf16 v[196:199], v[32:35], v[112:115], v[196:199]
  v_mfma_f32_16x16x32_bf16 v[204:207], v[32:35], v[96:99], v[204:207]
  s_waitcnt lgkmcnt(10)
  v_mfma_f32_16x16x32_bf16 v[200:203], v[20:23], v[92:95], 0
  v_mfma_f32_16x16x32_bf16 v[208:211], v[20:23], v[100:103], 0
  v_mfma_f32_16x16x32_bf16 v[200:203], v[36:39], v[108:111], v[200:203]
  v_mfma_f32_16x16x32_bf16 v[208:211], v[36:39], v[92:95], v[208:211]
  buffer_load_dwordx4 v1, s[16:19], s24 offen offset:3072 lds
  s_waitcnt lgkmcnt(8)
  v_mfma_f32_16x16x32_bf16 v[200:203], v[24:27], v[96:99], v[200:203]
  v_mfma_f32_16x16x32_bf16 v[208:211], v[24:27], v[104:107], v[208:211]
  v_mfma_f32_16x16x32_bf16 v[200:203], v[40:43], v[112:115], v[200:203]
  v_mfma_f32_16x16x32_bf16 v[208:211], v[40:43], v[96:99], v[208:211]
  s_waitcnt lgkmcnt(6)
  v_mfma_f32_16x16x32_bf16 v[212:215], v[44:47], v[92:95], 0
  v_mfma_f32_16x16x32_bf16 v[220:223], v[44:47], v[100:103], 0
  v_mfma_f32_16x16x32_bf16 v[212:215], v[60:63], v[108:111], v[212:215]
  v_cvt_pk_bf16_f32 v172, v196, v197
  v_cvt_pk_bf16_f32 v173, v198, v199
  v_mfma_f32_16x16x32_bf16 v[220:223], v[60:63], v[92:95], v[220:223]
  v_cvt_pk_bf16_f32 v174, v200, v201
  s_waitcnt lgkmcnt(4)
  v_mfma_f32_16x16x32_bf16 v[212:215], v[48:51], v[96:99], v[212:215]
  v_cvt_pk_bf16_f32 v175, v202, v203
  v_cvt_pk_bf16_f32 v176, v204, v205
  v_mfma_f32_16x16x32_bf16 v[220:223], v[48:51], v[104:107], v[220:223]
  v_cvt_pk_bf16_f32 v177, v206, v207
  v_mfma_f32_16x16x32_bf16 v[212:215], v[64:67], v[112:115], v[212:215]
  v_cvt_pk_bf16_f32 v178, v208, v209
  v_mfma_f32_16x16x32_bf16 v[220:223], v[64:67], v[96:99], v[220:223]
  v_cvt_pk_bf16_f32 v179, v210, v211
  s_mov_b32 vcc_lo, 0x55555555
  s_waitcnt lgkmcnt(2)
  v_mfma_f32_16x16x32_bf16 v[216:219], v[52:55], v[92:95], 0
  s_mov_b32 vcc_hi, 0x55555555
  v_mfma_f32_16x16x32_bf16 v[224:227], v[52:55], v[100:103], 0
  v_cndmask_b32_dpp v236, v176, v172, vcc quad_perm:[1,0,3,2] row_mask:0xf bank_mask:0xf
  v_mfma_f32_16x16x32_bf16 v[216:219], v[68:71], v[108:111], v[216:219]
  v_cndmask_b32_dpp v237, v177, v173, vcc quad_perm:[1,0,3,2] row_mask:0xf bank_mask:0xf
  v_cndmask_b32_dpp v238, v178, v174, vcc quad_perm:[1,0,3,2] row_mask:0xf bank_mask:0xf
  v_mfma_f32_16x16x32_bf16 v[224:227], v[68:71], v[92:95], v[224:227]
  v_cndmask_b32_dpp v239, v179, v175, vcc quad_perm:[1,0,3,2] row_mask:0xf bank_mask:0xf
  s_waitcnt lgkmcnt(0)
  v_mfma_f32_16x16x32_bf16 v[216:219], v[56:59], v[96:99], v[216:219]
  s_not_b64 vcc, vcc
  v_mfma_f32_16x16x32_bf16 v[224:227], v[56:59], v[104:107], v[224:227]
  v_cndmask_b32_dpp v244, v172, v176, vcc quad_perm:[1,0,3,2] row_mask:0xf bank_mask:0xf
  v_cndmask_b32_dpp v245, v173, v177, vcc quad_perm:[1,0,3,2] row_mask:0xf bank_mask:0xf
  v_mfma_f32_16x16x32_bf16 v[216:219], v[72:75], v[112:115], v[216:219]
  v_cndmask_b32_dpp v246, v174, v178, vcc quad_perm:[1,0,3,2] row_mask:0xf bank_mask:0xf
  v_mfma_f32_16x16x32_bf16 v[224:227], v[72:75], v[96:99], v[224:227]
  v_cndmask_b32_dpp v247, v175, v179, vcc quad_perm:[1,0,3,2] row_mask:0xf bank_mask:0xf
  v_cvt_pk_bf16_f32 v228, v212, v213
  v_cvt_pk_bf16_f32 v229, v214, v215
  s_nop 2
  v_cvt_pk_bf16_f32 v230, v216, v217
  v_cvt_pk_bf16_f32 v231, v218, v219
  v_cvt_pk_bf16_f32 v232, v220, v221
  v_cvt_pk_bf16_f32 v233, v222, v223
  v_cvt_pk_bf16_f32 v234, v224, v225
  v_cvt_pk_bf16_f32 v235, v226, v227
  s_mov_b32 vcc_lo, 0x55555555
  s_mov_b32 vcc_hi, 0x55555555
  v_cndmask_b32_dpp v240, v232, v228, vcc quad_perm:[1,0,3,2] row_mask:0xf bank_mask:0xf
  v_cndmask_b32_dpp v241, v233, v229, vcc quad_perm:[1,0,3,2] row_mask:0xf bank_mask:0xf
  v_cndmask_b32_dpp v242, v234, v230, vcc quad_perm:[1,0,3,2] row_mask:0xf bank_mask:0xf
  v_cndmask_b32_dpp v243, v235, v231, vcc quad_perm:[1,0,3,2] row_mask:0xf bank_mask:0xf
  s_not_b64 vcc, vcc
  v_cndmask_b32_dpp v248, v228, v232, vcc quad_perm:[1,0,3,2] row_mask:0xf bank_mask:0xf
  v_cndmask_b32_dpp v249, v229, v233, vcc quad_perm:[1,0,3,2] row_mask:0xf bank_mask:0xf
  v_cndmask_b32_dpp v250, v230, v234, vcc quad_perm:[1,0,3,2] row_mask:0xf bank_mask:0xf
  v_cndmask_b32_dpp v251, v231, v235, vcc quad_perm:[1,0,3,2] row_mask:0xf bank_mask:0xf
  s_mov_b32 vcc_lo, 0x33333333
  s_mov_b32 vcc_hi, 0x33333333
  s_add_u32 s41, s40, 82944
  v_cndmask_b32_dpp v28, v240, v236, vcc quad_perm:[2,3,0,1] row_mask:0xf bank_mask:0xf
  v_cndmask_b32_dpp v29, v241, v237, vcc quad_perm:[2,3,0,1] row_mask:0xf bank_mask:0xf
  v_cndmask_b32_dpp v30, v242, v238, vcc quad_perm:[2,3,0,1] row_mask:0xf bank_mask:0xf
  v_cndmask_b32_dpp v31, v243, v239, vcc quad_perm:[2,3,0,1] row_mask:0xf bank_mask:0xf
  buffer_store_dwordx4 v[28:31], v191, s[36:39], s40 offen sc1
  v_cndmask_b32_dpp v32, v248, v244, vcc quad_perm:[2,3,0,1] row_mask:0xf bank_mask:0xf
  v_cndmask_b32_dpp v33, v249, v245, vcc quad_perm:[2,3,0,1] row_mask:0xf bank_mask:0xf
  v_cndmask_b32_dpp v34, v250, v246, vcc quad_perm:[2,3,0,1] row_mask:0xf bank_mask:0xf
  v_cndmask_b32_dpp v35, v251, v247, vcc quad_perm:[2,3,0,1] row_mask:0xf bank_mask:0xf
  buffer_store_dwordx4 v[32:35], v191, s[36:39], s41 offen sc1
  s_not_b64 vcc, vcc
  s_add_u32 s42, s40, 165888
  s_add_u32 s43, s40, 248832
  v_cndmask_b32_dpp v36, v236, v240, vcc quad_perm:[2,3,0,1] row_mask:0xf bank_mask:0xf
  v_cndmask_b32_dpp v37, v237, v241, vcc quad_perm:[2,3,0,1] row_mask:0xf bank_mask:0xf
  v_cndmask_b32_dpp v38, v238, v242, vcc quad_perm:[2,3,0,1] row_mask:0xf bank_mask:0xf
  v_cndmask_b32_dpp v39, v239, v243, vcc quad_perm:[2,3,0,1] row_mask:0xf bank_mask:0xf
  buffer_store_dwordx4 v[36:39], v191, s[36:39], s42 offen sc1
  v_cndmask_b32_dpp v40, v244, v248, vcc quad_perm:[2,3,0,1] row_mask:0xf bank_mask:0xf
  v_cndmask_b32_dpp v41, v245, v249, vcc quad_perm:[2,3,0,1] row_mask:0xf bank_mask:0xf
  v_cndmask_b32_dpp v42, v246, v250, vcc quad_perm:[2,3,0,1] row_mask:0xf bank_mask:0xf
  v_cndmask_b32_dpp v43, v247, v251, vcc quad_perm:[2,3,0,1] row_mask:0xf bank_mask:0xf
  buffer_store_dwordx4 v[40:43], v191, s[36:39], s43 offen sc1
  s_waitcnt vmcnt(0)
  s_branch K3_join
K3_w2:
  v_lshrrev_b32 v2, 6, v0
  v_and_b32 v3, 63, v0
  v_readfirstlane_b32 s38, v2
  v_and_b32 v4, 15, v3
  v_lshrrev_b32 v5, 4, v3
  s_sub_u32 s39, s2, 161
  s_lshl_b32 s39, s39, 2
  s_add_u32 s39, s39, s38
  s_mov_b32 s45, s39
  s_mul_i32 s47, s45, 6554
  s_lshr_b32 s47, s47, 16
  s_mul_i32 s44, s47, 10
  s_sub_u32 s46, s45, s44
  s_mul_i32 s48, s47, 5120
  s_lshl_b32 s51, s46, 2
  s_mul_i32 s52, s51, 52
  s_lshr_b32 s52, s52, 8
  s_mul_i32 s52, s52, 265
  s_add_u32 s40, s52, s51
  s_lshl_b32 s40, s40, 10
  s_add_u32 s40, s40, s48
  s_lshl_b32 s51, s46, 2
  s_add_u32 s51, s51, 1
  s_mul_i32 s52, s51, 52
  s_lshr_b32 s52, s52, 8
  s_mul_i32 s52, s52, 265
  s_add_u32 s41, s52, s51
  s_lshl_b32 s41, s41, 10
  s_add_u32 s41, s41, s48
  s_lshl_b32 s51, s46, 2
  s_add_u32 s51, s51, 2
  s_mul_i32 s52, s51, 52
  s_lshr_b32 s52, s52, 8
  s_mul_i32 s52, s52, 265
  s_add_u32 s42, s52, s51
  s_lshl_b32 s42, s42, 10
  s_add_u32 s42, s42, s48
  s_lshl_b32 s51, s46, 2
  s_add_u32 s51, s51, 3
  s_mul_i32 s52, s51, 52
  s_lshr_b32 s52, s52, 8
  s_mul_i32 s52, s52, 265
  s_add_u32 s43, s52, s51
  s_lshl_b32 s43, s43, 10
  s_add_u32 s43, s43, s48
  s_cmp_ge_u32 s47, 48
  s_movk_i32 s49, 5120
  s_movk_i32 s50, 20480
  s_cselect_b32 s50, s49, s50
  s_cselect_b32 s49, 10240, s49
  v_mul_lo_u32 v9, v5, s49
  v_lshl_add_u32 v9, v4, 3, v9
  v_add_u32 v10, s50, v9
  s_mul_i32 s44, s47, 40960
  s_lshl_b32 s46, s46, 7
  s_add_u32 s44, s44, s46
  s_waitcnt lgkmcnt(0)
  s_mov_b32 s28, s10
  s_mov_b32 s29, s11
  s_mov_b32 s30, 2211840
  s_mov_b32 s31, 0x20000
  s_add_u32 s32, s4, 25165824
  s_addc_u32 s33, s5, 0
  s_mov_b32 s34, 2211840
  s_mov_b32 s35, 0x20000
  buffer_load_dwordx2 v[12:13], v9, s[28:31], s44 offen offset:0
  buffer_load_dwordx2 v[14:15], v9, s[28:31], s44 offen offset:1280
  buffer_load_dwordx2 v[16:17], v9, s[28:31], s44 offen offset:2560
  buffer_load_dwordx2 v[18:19], v9, s[28:31], s44 offen offset:3840
  buffer_load_dwordx2 v[20:21], v10, s[28:31], s44 offen offset:0
  buffer_load_dwordx2 v[22:23], v10, s[28:31], s44 offen offset:1280
  buffer_load_dwordx2 v[24:25], v10, s[28:31], s44 offen offset:2560
  buffer_load_dwordx2 v[26:27], v10, s[28:31], s44 offen offset:3840
  s_add_u32 s51, s39, 380
  s_cmp_lt_u32 s51, 540
  s_cselect_b32 s51, s51, s39
  s_mul_i32 s53, s51, 6554
  s_lshr_b32 s53, s53, 16
  s_mul_i32 s50, s53, 10
  s_sub_u32 s52, s51, s50
  s_mul_i32 s54, s53, 5120
  s_lshl_b32 s57, s52, 2
  s_mul_i32 s58, s57, 52
  s_lshr_b32 s58, s58, 8
  s_mul_i32 s58, s58, 265
  s_add_u32 s46, s58, s57
  s_lshl_b32 s46, s46, 10
  s_add_u32 s46, s46, s54
  s_lshl_b32 s57, s52, 2
  s_add_u32 s57, s57, 1
  s_mul_i32 s58, s57, 52
  s_lshr_b32 s58, s58, 8
  s_mul_i32 s58, s58, 265
  s_add_u32 s47, s58, s57
  s_lshl_b32 s47, s47, 10
  s_add_u32 s47, s47, s54
  s_lshl_b32 s57, s52, 2
  s_add_u32 s57, s57, 2
  s_mul_i32 s58, s57, 52
  s_lshr_b32 s58, s58, 8
  s_mul_i32 s58, s58, 265
  s_add_u32 s48, s58, s57
  s_lshl_b32 s48, s48, 10
  s_add_u32 s48, s48, s54
  s_lshl_b32 s57, s52, 2
  s_add_u32 s57, s57, 3
  s_mul_i32 s58, s57, 52
  s_lshr_b32 s58, s58, 8
  s_mul_i32 s58, s58, 265
  s_add_u32 s49, s58, s57
  s_lshl_b32 s49, s49, 10
  s_add_u32 s49, s49, s54
  s_cmp_ge_u32 s53, 48
  s_movk_i32 s55, 5120
  s_movk_i32 s56, 20480
  s_cselect_b32 s56, s55, s56
  s_cselect_b32 s55, 10240, s55
  v_mul_lo_u32 v28, v5, s55
  v_lshl_add_u32 v28, v4, 3, v28
  v_add_u32 v29, s56, v28
  s_mul_i32 s50, s53, 40960
  s_lshl_b32 s52, s52, 7
  s_add_u32 s50, s50, s52
  buffer_load_dwordx2 v[30:31], v28, s[28:31], s50 offen offset:0
  buffer_load_dwordx2 v[32:33], v28, s[28:31], s50 offen offset:1280
  buffer_load_dwordx2 v[34:35], v28, s[28:31], s50 offen offset:2560
  buffer_load_dwordx2 v[36:37], v28, s[28:31], s50 offen offset:3840
  buffer_load_dwordx2 v[38:39], v29, s[28:31], s50 offen offset:0
  buffer_load_dwordx2 v[40:41], v29, s[28:31], s50 offen offset:1280
  buffer_load_dwordx2 v[42:43], v29, s[28:31], s50 offen offset:2560
  buffer_load_dwordx2 v[44:45], v29, s[28:31], s50 offen offset:3840
  s_mov_b32 s16, s4
  s_mov_b32 s17, s5
  s_mov_b32 s18, 41943040
  s_mov_b32 s19, 0x20000
  v_lshrrev_b32 v7, 2, v4
  v_lshlrev_b32 v8, 12, v2
  v_lshl_add_u32 v7, v7, 10, v8
  v_lshl_add_u32 v7, v5, 8, v7
  v_and_b32 v6, 3, v4
  v_lshl_add_u32 v7, v6, 6, v7
  v_lshlrev_b32 v6, 4, v3
  v_add_u32 v8, v6, v8
  s_mov_b32 s36, 0x05040100
  s_mov_b32 s37, 0x07060302
  s_waitcnt vmcnt(8)
  v_perm_b32 v48, v14, v12, s36
  v_perm_b32 v49, v18, v16, s36
  v_perm_b32 v50, v22, v20, s36
  v_perm_b32 v51, v26, v24, s36
  ds_write_b128 v7, v[48:51] offset:0
  v_perm_b32 v52, v14, v12, s37
  v_perm_b32 v53, v18, v16, s37
  v_perm_b32 v54, v22, v20, s37
  v_perm_b32 v55, v26, v24, s37
  ds_write_b128 v7, v[52:55] offset:16
  v_perm_b32 v56, v15, v13, s36
  v_perm_b32 v57, v19, v17, s36
  v_perm_b32 v58, v23, v21, s36
  v_perm_b32 v59, v27, v25, s36
  ds_write_b128 v7, v[56:59] offset:32
  v_perm_b32 v60, v15, v13, s37
  v_perm_b32 v61, v19, v17, s37
  v_perm_b32 v62, v23, v21, s37
  v_perm_b32 v63, v27, v25, s37
  ds_write_b128 v7, v[60:63] offset:48
  s_waitcnt vmcnt(0)
  v_perm_b32 v64, v32, v30, s36
  v_perm_b32 v65, v36, v34, s36
  v_perm_b32 v66, v40, v38, s36
  v_perm_b32 v67, v44, v42, s36
  ds_write_b128 v7, v[64:67] offset:16384
  v_perm_b32 v68, v32, v30, s37
  v_perm_b32 v69, v36, v34, s37
  v_perm_b32 v70, v40, v38, s37
  v_perm_b32 v71, v44, v42, s37
  ds_write_b128 v7, v[68:71] offset:16400
  v_perm_b32 v72, v33, v31, s36
  v_perm_b32 v73, v37, v35, s36
  v_perm_b32 v74, v41, v39, s36
  v_perm_b32 v75, v45, v43, s36
  ds_write_b128 v7, v[72:75] offset:16416
  v_perm_b32 v76, v33, v31, s37
  v_perm_b32 v77, v37, v35, s37
  v_perm_b32 v78, v41, v39, s37
  v_perm_b32 v79, v45, v43, s37
  ds_write_b128 v7, v[76:79] offset:16432
  s_waitcnt lgkmcnt(4)
  ds_read_b128 v[48:51], v8 offset:0
  ds_read_b128 v[52:55], v8 offset:1024
  ds_read_b128 v[56:59], v8 offset:2048
  ds_read_b128 v[60:63], v8 offset:3072
  s_waitcnt lgkmcnt(4)
  ds_read_b128 v[64:67], v8 offset:16384
  ds_read_b128 v[68:71], v8 offset:17408
  ds_read_b128 v[72:75], v8 offset:18432
  ds_read_b128 v[76:79], v8 offset:19456
  s_waitcnt lgkmcnt(7)
  buffer_store_dwordx4 v[48:51], v6, s[32:35], s40 offen sc1
  s_waitcnt lgkmcnt(6)
  buffer_store_dwordx4 v[52:55], v6, s[32:35], s41 offen sc1
  s_waitcnt lgkmcnt(5)
  buffer_store_dwordx4 v[56:59], v6, s[32:35], s42 offen sc1
  s_waitcnt lgkmcnt(4)
  buffer_store_dwordx4 v[60:63], v6, s[32:35], s43 offen sc1
  s_waitcnt lgkmcnt(3)
  buffer_store_dwordx4 v[64:67], v6, s[32:35], s46 offen sc1
  s_waitcnt lgkmcnt(2)
  buffer_store_dwordx4 v[68:71], v6, s[32:35], s47 offen sc1
  s_waitcnt lgkmcnt(1)
  buffer_store_dwordx4 v[72:75], v6, s[32:35], s48 offen sc1
  s_waitcnt lgkmcnt(0)
  buffer_store_dwordx4 v[76:79], v6, s[32:35], s49 offen sc1
  s_add_u32 m0, s20, 0
  s_add_u32 s24, s22, 0
  buffer_load_dwordx4 v1, s[16:19], s24 offen offset:0 lds
  buffer_load_dwordx4 v1, s[16:19], s24 offen offset:1024 lds
  buffer_load_dwordx4 v1, s[16:19], s24 offen offset:2048 lds
  buffer_load_dwordx4 v1, s[16:19], s24 offen offset:3072 lds
  s_add_u32 m0, s20, 4096
  s_add_u32 s24, s22, 4096
  buffer_load_dwordx4 v1, s[16:19], s24 offen offset:0 lds
  buffer_load_dwordx4 v1, s[16:19], s24 offen offset:1024 lds
  buffer_load_dwordx4 v1, s[16:19], s24 offen offset:2048 lds
  buffer_load_dwordx4 v1, s[16:19], s24 offen offset:3072 lds
  s_add_u32 m0, s20, 8192
  s_add_u32 s24, s22, 8192
  buffer_load_dwordx4 v1, s[16:19], s24 offen offset:0 lds
  buffer_load_dwordx4 v1, s[16:19], s24 offen offset:1024 lds
  buffer_load_dwordx4 v1, s[16:19], s24 offen offset:2048 lds
  buffer_load_dwordx4 v1, s[16:19], s24 offen offset:3072 lds
  s_waitcnt vmcnt(12)
K3_join:
  s_barrier
  v_cmp_gt_u32 vcc, 8, v0
  v_lshlrev_b32 v2, 10, v0
  v_mov_b32 v3, 1
  s_lshl_b32 s24, s2, 2
  s_add_u32 s24, s24, 37752832
  s_mov_b64 exec, vcc
  s_cbranch_execz K3_nfl
  buffer_store_dword v3, v2, s[16:19], s24 offen sc1
K3_nfl:
  s_mov_b64 exec, -1
  s_bfe_u32 s40, s2, 0x20001
  s_lshl_b32 s40, s40, 2
  s_lshr_b32 s43, s2, 6
  s_add_u32 s40, s40, s43
  s_and_b32 s44, s2, 1
  s_lshl_b32 s43, s44, 3
  s_bfe_u32 s41, s2, 0x30003
  s_add_u32 s41, s41, s43
  s_lshl_b32 s43, s44, 2
  s_bfe_u32 s61, s2, 0x20003
  s_add_u32 s61, s61, s43
  s_lshl_b32 s42, s40, 4
  s_add_u32 s42, s42, s41
  s_movk_i32 s63, 1280
  v_lshrrev_b32 v28, 6, v0
  v_lshlrev_b32 v29, 4, v0
  v_readfirstlane_b32 s45, v28
  v_and_b32 v3, 15, v0
  v_bfe_u32 v4, v0, 4, 2
  v_and_b32 v1, 0x3f0, v29
  s_nop 0
  s_and_b32 s46, s45, 1
  s_lshr_b32 s47, s45, 1
  s_lshr_b32 s43, s42, 2
  s_lshl_b32 s43, s43, 5
  s_and_b32 s44, s42, 3
  s_lshl_b32 s44, s44, 2
  s_add_u32 s43, s43, s44
  s_mul_i32 s48, s43, 1280
  v_lshlrev_b32 v32, 4, v4
  v_xor_b32 v30, v32, v29
  s_cmp_ge_u32 s45, 1
  s_cselect_b32 s58, 15360, 0
  s_add_u32 s58, s58, s48
  s_add_u32 s58, s58, 4096
  s_add_u32 s59, s48, 23552
  v_and_b32 v33, 3, v0
  s_sub_u32 s44, s41, 12
  s_cmp_ge_u32 s41, 12
  s_cselect_b32 s44, s44, s41
  s_lshl_b32 s44, s44, 5
  s_add_u32 s44, s44, 2880
  s_mul_i32 s43, s41, 192
  v_lshrrev_b32 v34, 2, v1
  v_mov_b32 v31, s44
  v_mov_b32 v32, s43
  v_cmp_eq_u32 vcc, 3, v4
  s_nop 1
  v_cndmask_b32 v32, v32, v31, vcc
  v_add_u32 v34, v34, v32
  s_lshr_b32 s43, s40, 1
  s_lshl_b32 s43, s43, 4
  s_add_u32 s43, s43, s41
  s_mul_i32 s43, s43, 20736
  s_and_b32 s44, s40, 1
  s_lshl_b32 s44, s44, 6
  s_add_u32 s43, s43, s44
  v_and_b32 v35, 0xfc0, v29
  v_add_u32 v35, v35, v29
  s_lshl_b32 s49, s45, 10
  s_mul_i32 s51, s45, 3
  s_min_u32 s51, s51, 7
  s_add_u32 s51, s51, 25
  s_lshl_b32 s51, s51, 10
  s_mul_i32 s50, s41, 143360
  s_add_u32 s50, s50, 20971520
  s_add_u32 s54, s50, 142336
  s_add_u32 s50, s50, s51
  s_add_u32 s51, s51, 21504
  s_waitcnt lgkmcnt(0)
  s_add_u32 s28, s4, s43
  s_addc_u32 s29, s5, 0
  s_add_u32 s28, s28, 8388608
  s_addc_u32 s29, s29, 0
  s_mov_b32 s30, 20544
  s_mov_b32 s31, 0x20000
  s_mov_b32 s32, s6
  s_mov_b32 s33, s7
  s_mov_b32 s34, 2621440
  s_mov_b32 s35, 0x20000
  s_add_u32 m0, s49, 47104
  s_nop 0
  buffer_load_dwordx4 v30, s[32:35], s48 offen lds
  s_add_u32 m0, s49, 51200
  s_cmp_ge_u32 s45, 2
  buffer_load_dwordx4 v30, s[32:35], s58 offen lds
  s_cbranch_scc1 K3_nx
  s_add_u32 m0, s49, 55296
  s_nop 0
  buffer_load_dwordx4 v30, s[32:35], s59 offen lds
K3_nx:
  s_mov_b32 s16, s4
  s_mov_b32 s17, s5
  s_mov_b32 s18, 41943040
  s_mov_b32 s19, 0x20000
  s_mov_b32 s36, s8
  s_mov_b32 s37, s9
  s_mov_b32 s38, 3456
  s_mov_b32 s39, 0x20000
  s_movk_i32 m0, 20736
  s_nop 0
  buffer_load_dword v34, s[36:39], 0 offen lds
  buffer_load_dwordx4 v[24:27], v1, s[16:19], s54 offen
  s_lshl_b32 s43, s45, 2
  s_min_u32 s43, s43, 9
  s_lshl_b32 s43, s43, 10
  s_add_u32 m0, s43, 21504
  s_add_u32 s43, s43, s54
  s_sub_u32 s43, s43, 142336
  buffer_load_dwordx4 v1, s[16:19], s43 offen offset:0 lds
  buffer_load_dwordx4 v1, s[16:19], s43 offen offset:1024 lds
  buffer_load_dwordx4 v1, s[16:19], s43 offen offset:2048 lds
  buffer_load_dwordx4 v1, s[16:19], s43 offen offset:3072 lds
  s_lshr_b32 s43, s2, 6
  s_lshl_b32 s43, s43, 2
  s_add_u32 s53, s43, s45
  s_mul_i32 s43, s53, 8960
  s_mul_i32 s44, s41, 143360
  s_add_u32 s43, s43, s44
  s_add_u32 s60, s43, 20971520
  v_lshlrev_b32 v7, 3, v1
  s_bfe_u32 s43, s2, 0x10005
  s_lshl_b32 s43, s43, 4
  s_add_u32 s43, s43, s53
  s_mul_i32 s43, s43, 2944
  s_mul_i32 s44, s61, 276480
  s_add_u32 s43, s43, s44
  s_add_u32 s60, s43, 25165824
  s_mul_i32 s55, s61, 54
  s_add_u32 s55, s55, s45
  s_mul_i32 s55, s55, 5120
  s_add_u32 s55, s55, 25165824
  s_add_u32 m0, s21, 12288
  s_add_u32 s24, s23, 12288
  buffer_load_dwordx4 v1, s[16:19], s24 offen offset:0 lds
  v_cvt_f32_u32 v107, v3
  v_cvt_f32_u32 v105, v4
  s_lshl_b32 s56, s47, 4
  v_cvt_f32_u32 v104, s56
  v_add_f32 v104, v104, v107
  v_mul_f32 v106, 0x3d000000, v104
  v_mul_f32 v92, 0x41000000, v105
  v_mul_f32 v92, v92, v106
  v_add_f32 v93, v92, v106
  buffer_load_dwordx4 v1, s[16:19], s24 offen offset:1024 lds
  v_add_f32 v94, v93, v106
  v_add_f32 v95, v94, v106
  v_add_f32 v96, v95, v106
  v_add_f32 v97, v96, v106
  v_add_f32 v98, v97, v106
  v_add_f32 v99, v98, v106
  v_cos_f32 v100, v92
  v_cos_f32 v101, v93
  v_sin_f32 v102, v92
  v_sin_f32 v103, v93
  buffer_load_dwordx4 v1, s[16:19], s24 offen offset:2048 lds
  v_cvt_pk_bf16_f32 v48, v100, v101
  v_cvt_pk_bf16_f32 v52, v102, v103
  v_cos_f32 v100, v94
  v_cos_f32 v101, v95
  v_sin_f32 v102, v94
  v_sin_f32 v103, v95
  v_cvt_pk_bf16_f32 v49, v100, v101
  v_cvt_pk_bf16_f32 v53, v102, v103
  v_cos_f32 v100, v96
  v_cos_f32 v101, v97
  buffer_load_dwordx4 v1, s[16:19], s24 offen offset:3072 lds
  v_sin_f32 v102, v96
  v_sin_f32 v103, v97
  v_cvt_pk_bf16_f32 v50, v100, v101
  v_cvt_pk_bf16_f32 v54, v102, v103
  v_cos_f32 v100, v98
  v_cos_f32 v101, v99
  v_sin_f32 v102, v98
  v_sin_f32 v103, v99
  v_cvt_pk_bf16_f32 v51, v100, v101
  v_cvt_pk_bf16_f32 v55, v102, v103
  s_add_u32 m0, s21, 16384
  s_add_u32 s24, s23, 16384
  buffer_load_dwordx4 v1, s[16:19], s24 offen offset:0 lds
  v_bfe_u32 v108, v0, 5, 1
  v_mul_u32_u24 v108, 0x8000, v108
  v_lshl_or_b32 v108, v108, 16, v108
  v_xor_b32 v32, 0x80008000, v108
  v_xor_b32 v56, v108, v48
  v_xor_b32 v60, v32, v52
  v_xor_b32 v57, v108, v49
  v_xor_b32 v61, v32, v53
  v_xor_b32 v58, v108, v50
  v_xor_b32 v62, v32, v54
  buffer_load_dwordx4 v1, s[16:19], s24 offen offset:1024 lds
  v_xor_b32 v59, v108, v51
  v_xor_b32 v63, v32, v55
  v_mul_f32 v106, 0x3acccccd, v104
  v_mul_f32 v92, v106, v105
  v_fmamk_f32 v93, v106, 0x40800000, v92
  v_fmamk_f32 v94, v106, 0x41000000, v92
  v_cos_f32 v64, v92
  v_sin_f32 v65, v92
  v_cos_f32 v66, v93
  buffer_load_dwordx4 v1, s[16:19], s24 offen offset:2048 lds
  v_sin_f32 v67, v93
  v_cos_f32 v68, v94
  v_sin_f32 v69, v94
  v_mul_f32 v106, 0x3d4ccccd, v107
  v_mul_f32 v92, v106, v105
  v_fmamk_f32 v93, v106, 0x40800000, v92
  v_fmamk_f32 v94, v106, 0x41000000, v92
  v_cos_f32 v100, v92
  v_sin_f32_e64 v101, -v92
  s_nop 0
  v_cvt_pk_bf16_f32 v72, v100, v101
  buffer_load_dwordx4 v1, s[16:19], s24 offen offset:3072 lds
  v_cos_f32 v100, v93
  v_sin_f32_e64 v101, -v93
  s_nop 0
  v_cvt_pk_bf16_f32 v73, v100, v101
  v_cos_f32 v100, v94
  v_sin_f32_e64 v101, -v94
  s_nop 0
  v_cvt_pk_bf16_f32 v74, v100, v101
  v_cvt_f32_u32 v106, v33
  v_add_f32 v106, 0x41800000, v106
  v_mul_f32 v106, 0x3d4ccccd, v106
  v_mul_f32 v92, v106, v105
  s_add_u32 m0, s21, 20480
  s_add_u32 s24, s23, 20480
  buffer_load_dwordx4 v1, s[16:19], s24 offen offset:0 lds
  v_fmamk_f32 v93, v106, 0x40800000, v92
  v_fmamk_f32 v94, v106, 0x41000000, v92
  v_cos_f32 v100, v92
  v_sin_f32_e64 v101, -v92
  s_nop 0
  v_cvt_pk_bf16_f32 v96, v100, v101
  v_cos_f32 v100, v93
  v_sin_f32_e64 v101, -v93
  s_nop 0
  v_cvt_pk_bf16_f32 v97, v100, v101
  v_cos_f32 v100, v94
  v_sin_f32_e64 v101, -v94
  buffer_load_dwordx4 v1, s[16:19], s24 offen offset:1024 lds
  v_cvt_pk_bf16_f32 v98, v100, v101
  v_mov_b32 v75, 0
  v_mov_b32 v76, 0
  v_mov_b32 v77, 0
  v_mov_b32 v78, 0
  v_mov_b32 v79, 0
  v_mov_b32 v80, 0
  v_mov_b32 v81, 0
  v_mov_b32 v82, 0
  v_mov_b32 v83, 0
  buffer_load_dwordx4 v1, s[16:19], s24 offen offset:2048 lds
  v_mov_b32 v84, 0
  v_mov_b32 v85, 0
  v_mov_b32 v86, 0
  v_mov_b32 v87, 0
  v_mov_b32 v88, 0
  v_mov_b32 v89, 0
  v_mov_b32 v90, 0
  v_mov_b32 v91, 0
  s_mov_b32 exec_lo, 0x00000000
  s_mov_b32 exec_hi, 0xffff0000
  v_mov_b32 v74, 0
  v_mov_b32 v98, 0
  s_mov_b32 exec_lo, 0x000f000f
  s_mov_b32 exec_hi, 0x000f000f
  v_mov_b32 v76, v96
  v_mov_b32 v77, v97
  v_mov_b32 v78, v98
  s_mov_b32 exec_lo, 0x00f000f0
  s_mov_b32 exec_hi, 0x00f000f0
  v_mov_b32 v80, v96
  v_mov_b32 v81, v97
  v_mov_b32 v82, v98
  s_mov_b32 exec_lo, 0x0f000f00
  s_mov_b32 exec_hi, 0x0f000f00
  v_mov_b32 v84, v96
  v_mov_b32 v85, v97
  v_mov_b32 v86, v98
  s_mov_b32 exec_lo, 0xf000f000
  s_mov_b32 exec_hi, 0xf000f000
  v_mov_b32 v88, v96
  v_mov_b32 v89, v97
  v_mov_b32 v90, v98
  s_mov_b64 exec, -1
  v_bfe_u32 v32, v0, 2, 2
  buffer_load_dwordx4 v1, s[16:19], s24 offen offset:3072 lds
  v_lshl_add_u32 v32, v4, 3, v32
  v_mad_u32_u24 v32, v32, 20, v33
  v_lshlrev_b32 v32, 5, v32
  s_lshl_b32 s44, s46, 3
  s_mov_b32 exec_lo, 0xffffffff
  s_mov_b32 exec_hi, 0x00000000
  v_add_u32 v32, s44, v32
  v_add_u32 v110, 0, v32
  v_add_u32 v111, 2560, v32
  v_add_u32 v112, 128, v32
  v_add_u32 v113, 2688, v32
  v_add_u32 v114, 256, v32
  v_add_u32 v115, 2816, v32
  s_mov_b32 exec_lo, 0x00000000
  s_mov_b32 exec_hi, 0xffffffff
  v_sub_u32 v32, s44, v32
  v_add_u32 v110, 20480, v32
  v_add_u32 v111, 17920, v32
  v_add_u32 v112, 20352, v32
  v_add_u32 v113, 17792, v32
  v_add_u32 v114, 20224, v32
  v_add_u32 v115, 17664, v32
  s_mov_b32 exec_lo, 0x00000000
  s_mov_b32 exec_hi, 0x11111110
  v_mov_b32 v110, 10304
  s_mov_b32 exec_lo, 0x00000000
  s_mov_b32 exec_hi, 0x11111111
  v_mov_b32 v111, 10304
  s_mov_b32 exec_lo, 0x00000000
  s_mov_b32 exec_hi, 0x44444444
  v_mov_b32 v114, 10304
  v_mov_b32 v115, 10304
  s_mov_b64 exec, -1
  v_and_b32 v32, 1, v4
  v_lshrrev_b32 v116, 1, v4
  s_lshl_b32 s43, s47, 8
  s_lshl_b32 s44, s46, 6
  s_add_u32 m0, s21, 24576
  s_add_u32 s24, s23, 24576
  buffer_load_dwordx4 v1, s[16:19], s24 offen offset:0 lds
  s_add_u32 s43, s43, s44
  v_lshl_add_u32 v122, v116, 7, s43
  v_lshlrev_b32 v119, 4, v3
  v_xor_b32 v118, v122, v119
  v_lshl_add_u32 v118, v3, 9, v118
  v_lshl_add_u32 v118, v32, 3, v118
  v_xor_b32 v119, 16, v118
  v_xor_b32 v120, 32, v118
  v_xor_b32 v121, 48, v118
  v_lshrrev_b32 v123, 2, v3
  buffer_load_dwordx4 v1, s[16:19], s24 offen offset:1024 lds
  v_xor_b32 v124, v123, v33
  v_lshl_add_u32 v122, v124, 4, v122
  v_lshl_add_u32 v122, v33, 9, v122
  v_lshl_add_u32 v122, v32, 3, v122
  v_add_u32 v122, 8192, v122
  v_lshlrev_b32 v125, 4, v32
  v_lshl_add_u32 v125, v116, 3, v125
  s_add_u32 s43, s44, 10368
  v_mov_b32 v126, s43
  s_lshl_b32 s44, s47, 5
  buffer_load_dwordx4 v1, s[16:19], s24 offen offset:2048 lds
  s_add_u32 s44, s44, s43
  v_add_u32 v125, s44, v125
  v_lshl_add_u32 v127, v123, 3, v126
  v_lshrrev_b32 v123, 5, v0
  v_lshlrev_b32 v123, 4, v123
  v_xor_b32 v123, v123, v29
  v_xor_b32 v124, 128, v123
  v_add_u32 v2, 4096, v1
  s_lshl_b32 s43, s47, 1
  v_add_u32 v116, s43, v116
  buffer_load_dwordx4 v1, s[16:19], s24 offen offset:3072 lds
  s_mul_i32 s43, s46, 5120
  s_add_u32 s43, s43, 47104
  v_lshl_add_u32 v32, v32, 3, s43
  v_lshl_add_u32 v30, v3, 6, v32
  v_lshrrev_b32 v31, 2, v3
  v_add_u32 v128, 0, v31
  v_and_b32 v128, 3, v128
  v_xor_b32 v128, v128, v116
  v_lshl_add_u32 v128, v128, 4, v30
  v_add_u32 v129, 1, v31
  s_add_u32 m0, s21, 28672
  s_add_u32 s24, s23, 28672
  buffer_load_dwordx4 v1, s[16:19], s24 offen offset:0 lds
  v_and_b32 v129, 3, v129
  v_xor_b32 v129, v129, v116
  v_lshl_add_u32 v129, v129, 4, v30
  v_add_u32 v130, 2, v31
  v_and_b32 v130, 3, v130
  v_xor_b32 v130, v130, v116
  v_lshl_add_u32 v130, v130, 4, v30
  v_add_u32 v131, 3, v31
  v_and_b32 v131, 3, v131
  v_xor_b32 v131, v131, v116
  v_lshl_add_u32 v131, v131, 4, v30
  v_xor_b32 v34, v31, v116
  v_lshl_add_u32 v32, v34, 4, v32
  v_mad_u32_u24 v32, v31, s63, v32
  v_lshl_add_u32 v31, v33, 6, v32
  s_and_b32 s44, s2, 7
  s_lshl_b32 s44, s44, 10
  s_add_u32 s43, s44, 37752832
  s_cmp_lg_u32 s45, 0
  s_cbranch_scc1 K3_xg
  s_mov_b32 s53, 0
  s_branch K3_pf
K3_pg:
  s_sleep 16
K3_pf:
  buffer_load_dwordx4 v[132:135], v1, s[16:19], s43 offen sc1
  s_add_u32 s53, s53, 1
  s_cmp_gt_u32 s53, 400000
  s_waitcnt vmcnt(0)
  s_cbranch_scc1 K3_xg
  v_and_b32 v132, v132, v133
  v_and_b32 v134, v134, v135
  v_and_b32 v6, v132, v134
  v_cmp_ne_u32 vcc, 1, v6
  s_cbranch_vccnz K3_pg
K3_xg:
  s_barrier
  s_add_u32 m0, s49, 0
  s_movk_i32 s44, 0
  buffer_load_dwordx4 v35, s[28:31], s44 offen sc1 lds
  s_add_u32 m0, s49, 4096
  s_movk_i32 s44, 8192
  buffer_load_dwordx4 v35, s[28:31], s44 offen sc1 lds
  s_add_u32 m0, s49, 8192
  s_movk_i32 s44, 16384
  buffer_load_dwordx4 v35, s[28:31], s44 offen sc1 lds
  s_add_u32 s62, s55, 0
  buffer_load_dwordx4 a[0:3], v1, s[16:19], s62 offen offset:0 sc1
  buffer_load_dwordx4 a[4:7], v1, s[16:19], s62 offen offset:1024 sc1
  buffer_load_dwordx4 a[8:11], v1, s[16:19], s62 offen offset:2048 sc1
  buffer_load_dwordx4 a[12:15], v1, s[16:19], s62 offen offset:3072 sc1
  buffer_load_dwordx4 a[16:19], v2, s[16:19], s62 offen offset:0 sc1
  s_add_u32 s62, s55, 20480
  buffer_load_dwordx4 a[20:23], v1, s[16:19], s62 offen offset:0 sc1
  buffer_load_dwordx4 a[24:27], v1, s[16:19], s62 offen offset:1024 sc1
  buffer_load_dwordx4 a[28:31], v1, s[16:19], s62 offen offset:2048 sc1
  s_mul_i32 s43, s42, 10240
  s_add_u32 s44, s43, 12582912
  s_add_u32 s28, s4, s44
  s_addc_u32 s29, s5, 0
  s_mov_b32 s30, 10240
  s_add_u32 s44, s43, 16777216
  s_add_u32 s36, s4, s44
  s_addc_u32 s37, s5, 0
  s_mov_b32 s38, 10240
  s_waitcnt vmcnt(8)
  s_barrier
  buffer_load_dwordx4 a[32:35], v1, s[16:19], s62 offen offset:3072 sc1
  ds_read_b64_tr_b16 v[136:137], v110 offset:0
  ds_read_b64_tr_b16 v[138:139], v111 offset:0
  ds_read_b64_tr_b16 v[140:141], v110 offset:16
  ds_read_b64_tr_b16 v[142:143], v111 offset:16
  ds_read_b64_tr_b16 v[144:145], v112 offset:0
  ds_read_b64_tr_b16 v[146:147], v113 offset:0
  ds_read_b64_tr_b16 v[148:149], v112 offset:16
  ds_read_b64_tr_b16 v[150:151], v113 offset:16
  ds_read_b64_tr_b16 v[152:153], v114 offset:0
  buffer_load_dwordx4 a[36:39], v2, s[16:19], s62 offen offset:0 sc1
  ds_read_b64_tr_b16 v[154:155], v115 offset:0
  ds_read_b64_tr_b16 v[156:157], v114 offset:16
  ds_read_b64_tr_b16 v[158:159], v115 offset:16
  ds_read_b64 v[36:37], v128 offset:0
  ds_read_b64 v[38:39], v129 offset:1280
  ds_read_b64 v[40:41], v130 offset:2560
  ds_read_b64 v[42:43], v131 offset:3840
  ds_read_b64 v[44:45], v31 offset:1024
  s_waitcnt lgkmcnt(13)
  s_add_u32 s62, s55, 40960
  buffer_load_dwordx4 a[40:43], v1, s[16:19], s62 offen offset:0 sc1
  v_mfma_f32_16x16x32_bf16 v[160:163], v[136:139], v[48:51], 0
  v_mfma_f32_16x16x32_bf16 v[164:167], v[136:139], v[52:55], 0
  v_mfma_f32_16x16x32_bf16 v[160:163], v[140:143], v[60:63], v[160:163]
  v_mfma_f32_16x16x32_bf16 v[164:167], v[140:143], v[56:59], v[164:167]
  s_waitcnt lgkmcnt(9)
  v_mfma_f32_16x16x32_bf16 v[168:171], v[144:147], v[48:51], 0
  v_mfma_f32_16x16x32_bf16 v[172:175], v[144:147], v[52:55], 0
  v_mfma_f32_16x16x32_bf16 v[168:171], v[148:151], v[60:63], v[168:171]
  v_mfma_f32_16x16x32_bf16 v[172:175], v[148:151], v[56:59], v[172:175]
  s_waitcnt lgkmcnt(5)
  buffer_load_dwordx4 a[44:47], v1, s[16:19], s62 offen offset:1024 sc1
  v_mfma_f32_16x16x32_bf16 v[176:179], v[152:155], v[48:51], 0
  v_mfma_f32_16x16x32_bf16 v[180:183], v[152:155], v[52:55], 0
  v_mfma_f32_16x16x32_bf16 v[176:179], v[156:159], v[60:63], v[176:179]
  v_mfma_f32_16x16x32_bf16 v[180:183], v[156:159], v[56:59], v[180:183]
  v_mov_b32 v187, 0
  v_mov_b32 v191, 0
  v_mov_b32 v195, 0
  v_mov_b32 v199, 0
  v_pk_mul_f32 v[136:137], v[160:161], v[64:65] op_sel_hi:[1,0]
  buffer_load_dwordx4 a[48:51], v1, s[16:19], s62 offen offset:2048 sc1
  v_pk_mul_f32 v[140:141], v[164:165], v[64:65] op_sel_hi:[1,0]
  v_pk_fma_f32 v[136:137], v[164:165], v[64:65], v[136:137] op_sel:[0,1,0] neg_lo:[1,0,0] neg_hi:[1,0,0]
  v_pk_fma_f32 v[140:141], v[160:161], v[64:65], v[140:141] op_sel:[0,1,0]
  v_pk_mul_f32 v[138:139], v[162:163], v[64:65] op_sel_hi:[1,0]
  v_pk_mul_f32 v[142:143], v[166:167], v[64:65] op_sel_hi:[1,0]
  v_pk_fma_f32 v[138:139], v[166:167], v[64:65], v[138:139] op_sel:[0,1,0] neg_lo:[1,0,0] neg_hi:[1,0,0]
  v_pk_fma_f32 v[142:143], v[162:163], v[64:65], v[142:143] op_sel:[0,1,0]
  v_cvt_pk_bf16_f32 v184, v136, v140
  v_cvt_pk_bf16_f32 v188, v137, v141
  v_cvt_pk_bf16_f32 v192, v138, v142
  buffer_load_dwordx4 a[52:55], v1, s[16:19], s62 offen offset:3072 sc1
  v_cvt_pk_bf16_f32 v196, v139, v143
  v_pk_mul_f32 v[144:145], v[168:169], v[66:67] op_sel_hi:[1,0]
  v_pk_mul_f32 v[148:149], v[172:173], v[66:67] op_sel_hi:[1,0]
  v_pk_fma_f32 v[144:145], v[172:173], v[66:67], v[144:145] op_sel:[0,1,0] neg_lo:[1,0,0] neg_hi:[1,0,0]
  v_pk_fma_f32 v[148:149], v[168:169], v[66:67], v[148:149] op_sel:[0,1,0]
  v_pk_mul_f32 v[146:147], v[170:171], v[66:67] op_sel_hi:[1,0]
  v_pk_mul_f32 v[150:151], v[174:175], v[66:67] op_sel_hi:[1,0]
  v_pk_fma_f32 v[146:147], v[174:175], v[66:67], v[146:147] op_sel:[0,1,0] neg_lo:[1,0,0] neg_hi:[1,0,0]
  v_pk_fma_f32 v[150:151], v[170:171], v[66:67], v[150:151] op_sel:[0,1,0]
  buffer_load_dwordx4 a[56:59], v2, s[16:19], s62 offen offset:0 sc1
  v_cvt_pk_bf16_f32 v185, v144, v148
  v_cvt_pk_bf16_f32 v189, v145, v149
  v_cvt_pk_bf16_f32 v193, v146, v150
  v_cvt_pk_bf16_f32 v197, v147, v151
  v_pk_mul_f32 v[152:153], v[176:177], v[68:69] op_sel_hi:[1,0]
  v_pk_mul_f32 v[156:157], v[180:181], v[68:69] op_sel_hi:[1,0]
  v_pk_fma_f32 v[152:153], v[180:181], v[68:69], v[152:153] op_sel:[0,1,0] neg_lo:[1,0,0] neg_hi:[1,0,0]
  v_pk_fma_f32 v[156:157], v[176:177], v[68:69], v[156:157] op_sel:[0,1,0]
  v_pk_mul_f32 v[154:155], v[178:179], v[68:69] op_sel_hi:[1,0]
  s_add_u32 s62, s55, 61440
  buffer_load_dwordx4 a[60:63], v1, s[16:19], s62 offen offset:0 sc1
  v_pk_mul_f32 v[158:159], v[182:183], v[68:69] op_sel_hi:[1,0]
  v_pk_fma_f32 v[154:155], v[182:183], v[68:69], v[154:155] op_sel:[0,1,0] neg_lo:[1,0,0] neg_hi:[1,0,0]
  v_pk_fma_f32 v[158:159], v[178:179], v[68:69], v[158:159] op_sel:[0,1,0]
  v_cvt_pk_bf16_f32 v186, v152, v156
  v_cvt_pk_bf16_f32 v190, v153, v157
  v_cvt_pk_bf16_f32 v194, v154, v158
  v_cvt_pk_bf16_f32 v198, v155, v159
  v_mfma_f32_16x16x32_bf16 v[160:163], v[184:187], v[72:75], 0
  v_mfma_f32_16x16x32_bf16 v[164:167], v[188:191], v[72:75], 0
  v_mfma_f32_16x16x32_bf16 v[168:171], v[192:195], v[72:75], 0
  v_mfma_f32_16x16x32_bf16 v[172:175], v[196:199], v[72:75], 0
  v_mfma_f32_16x16x32_bf16 v[176:179], v[184:187], v[76:79], 0
  v_mfma_f32_16x16x32_bf16 v[176:179], v[188:191], v[80:83], v[176:179]
  v_mfma_f32_16x16x32_bf16 v[176:179], v[192:195], v[84:87], v[176:179]
  v_mfma_f32_16x16x32_bf16 v[176:179], v[196:199], v[88:91], v[176:179]
  buffer_load_dwordx4 a[64:67], v1, s[16:19], s62 offen offset:1024 sc1
  s_waitcnt lgkmcnt(0)
  v_lshlrev_b32 v136, 16, v36
  v_and_b32 v137, 0xffff0000, v36
  v_lshlrev_b32 v138, 16, v37
  v_and_b32 v139, 0xffff0000, v37
  v_lshlrev_b32 v140, 16, v38
  v_and_b32 v141, 0xffff0000, v38
  v_lshlrev_b32 v142, 16, v39
  v_and_b32 v143, 0xffff0000, v39
  v_lshlrev_b32 v144, 16, v40
  v_and_b32 v145, 0xffff0000, v40
  v_lshlrev_b32 v146, 16, v41
  v_and_b32 v147, 0xffff0000, v41
  v_lshlrev_b32 v148, 16, v42
  v_and_b32 v149, 0xffff0000, v42
  v_lshlrev_b32 v150, 16, v43
  buffer_load_dwordx4 a[68:71], v1, s[16:19], s62 offen offset:2048 sc1
  v_and_b32 v151, 0xffff0000, v43
  v_lshlrev_b32 v152, 16, v44
  v_and_b32 v153, 0xffff0000, v44
  v_lshlrev_b32 v154, 16, v45
  v_and_b32 v155, 0xffff0000, v45
  v_pk_add_f32 v[136:137], v[136:137], v[160:161]
  v_pk_add_f32 v[138:139], v[138:139], v[162:163]
  v_pk_add_f32 v[140:141], v[140:141], v[164:165]
  v_pk_add_f32 v[142:143], v[142:143], v[166:167]
  v_pk_add_f32 v[144:145], v[144:145], v[168:169]
  v_pk_add_f32 v[146:147], v[146:147], v[170:171]
  v_pk_add_f32 v[148:149], v[148:149], v[172:173]
  v_pk_add_f32 v[150:151], v[150:151], v[174:175]
  v_pk_add_f32 v[152:153], v[152:153], v[176:177]
  v_pk_add_f32 v[154:155], v[154:155], v[178:179]
  v_cvt_pk_bf16_f32 v36, v136, v137
  buffer_load_dwordx4 a[72:75], v1, s[16:19], s62 offen offset:3072 sc1
  v_cvt_pk_bf16_f32 v37, v138, v139
  v_cvt_pk_bf16_f32 v38, v140, v141
  v_cvt_pk_bf16_f32 v39, v142, v143
  v_cvt_pk_bf16_f32 v40, v144, v145
  v_cvt_pk_bf16_f32 v41, v146, v147
  v_cvt_pk_bf16_f32 v42, v148, v149
  v_cvt_pk_bf16_f32 v43, v150, v151
  v_cvt_pk_bf16_f32 v44, v152, v153
  v_cvt_pk_bf16_f32 v45, v154, v155
  v_mov_b32 v100, 0x3f803f80
  v_dot2_f32_bf16 v200, v36, v100, 0
  v_dot2_f32_bf16 v201, v36, v36, 0
  v_dot2_f32_bf16 v202, v38, v100, 0
  v_dot2_f32_bf16 v203, v38, v38, 0
  v_dot2_f32_bf16 v204, v40, v100, 0
  v_dot2_f32_bf16 v205, v40, v40, 0
  buffer_load_dwordx4 a[76:79], v2, s[16:19], s62 offen offset:0 sc1
  v_dot2_f32_bf16 v206, v42, v100, 0
  v_dot2_f32_bf16 v207, v42, v42, 0
  v_dot2_f32_bf16 v208, v44, v100, 0
  v_dot2_f32_bf16 v209, v44, v44, 0
  v_dot2_f32_bf16 v200, v37, v100, v200
  v_dot2_f32_bf16 v201, v37, v37, v201
  v_dot2_f32_bf16 v202, v39, v100, v202
  v_dot2_f32_bf16 v203, v39, v39, v203
  v_dot2_f32_bf16 v204, v41, v100, v204
  v_dot2_f32_bf16 v205, v41, v41, v205
  v_dot2_f32_bf16 v206, v43, v100, v206
  v_dot2_f32_bf16 v207, v43, v43, v207
  v_dot2_f32_bf16 v208, v45, v100, v208
  v_dot2_f32_bf16 v209, v45, v45, v209
  ds_write_b64 v118, v[36:37] offset:10496
  ds_write_b64 v119, v[38:39] offset:10496
  ds_write_b64 v120, v[40:41] offset:10496
  s_add_u32 s62, s55, 81920
  buffer_load_dwordx4 a[80:83], v1, s[16:19], s62 offen offset:0 sc1
  ds_write_b64 v121, v[42:43] offset:10496
  ds_write_b64 v122, v[44:45] offset:10496
  s_mov_b32 exec_lo, 0x000f000f
  s_mov_b32 exec_hi, 0x000f000f
  v_pk_add_f32 v[200:201], v[200:201], v[208:209]
  s_mov_b32 exec_lo, 0x00f000f0
  s_mov_b32 exec_hi, 0x00f000f0
  v_pk_add_f32 v[202:203], v[202:203], v[208:209]
  s_mov_b32 exec_lo, 0x0f000f00
  s_mov_b32 exec_hi, 0x0f000f00
  v_pk_add_f32 v[204:205], v[204:205], v[208:209]
  s_mov_b32 exec_lo, 0xf000f000
  s_mov_b32 exec_hi, 0xf000f000
  v_pk_add_f32 v[206:207], v[206:207], v[208:209]
  s_mov_b64 exec, -1
  v_permlane32_swap_b32 v200, v202
  v_permlane32_swap_b32 v204, v206
  v_permlane32_swap_b32 v201, v203
  v_permlane32_swap_b32 v205, v207
  v_pk_add_f32 v[200:201], v[200:201], v[202:203]
  v_pk_add_f32 v[204:205], v[204:205], v[206:207]
  s_nop 1
  v_permlane16_swap_b32 v200, v204
  v_permlane16_swap_b32 v201, v205
  v_pk_add_f32 v[200:201], v[200:201], v[204:205]
  s_nop 1
  v_add_f32_dpp v200, v200, v200 row_ror:8 row_mask:0xf bank_mask:0xf
  v_add_f32_dpp v201, v201, v201 row_ror:8 row_mask:0xf bank_mask:0xf
  v_lshlrev_b32 v136, 16, v36
  v_and_b32 v137, 0xffff0000, v36
  buffer_load_dwordx4 a[84:87], v1, s[16:19], s62 offen offset:1024 sc1
  v_add_f32_dpp v200, v200, v200 row_ror:4 row_mask:0xf bank_mask:0xf
  v_add_f32_dpp v201, v201, v201 row_ror:4 row_mask:0xf bank_mask:0xf
  v_lshlrev_b32 v138, 16, v37
  v_and_b32 v139, 0xffff0000, v37
  v_add_f32_dpp v200, v200, v200 row_ror:2 row_mask:0xf bank_mask:0xf
  v_add_f32_dpp v201, v201, v201 row_ror:2 row_mask:0xf bank_mask:0xf
  v_lshlrev_b32 v140, 16, v38
  v_and_b32 v141, 0xffff0000, v38
  v_add_f32_dpp v200, v200, v200 row_ror:1 row_mask:0xf bank_mask:0xf
  v_add_f32_dpp v201, v201, v201 row_ror:1 row_mask:0xf bank_mask:0xf
  v_lshlrev_b32 v142, 16, v39
  v_and_b32 v143, 0xffff0000, v39
  s_mov_b32 exec_lo, 0x00010001
  s_mov_b32 exec_hi, 0x00010001
  ds_write_b64 v125, v[200:201]
  s_mov_b64 exec, -1
  v_lshlrev_b32 v144, 16, v40
  v_and_b32 v145, 0xffff0000, v40
  v_lshlrev_b32 v146, 16, v41
  v_and_b32 v147, 0xffff0000, v41
  v_lshlrev_b32 v148, 16, v42
  v_and_b32 v149, 0xffff0000, v42
  v_lshlrev_b32 v150, 16, v43
  v_and_b32 v151, 0xffff0000, v43
  v_lshlrev_b32 v152, 16, v44
  v_and_b32 v153, 0xffff0000, v44
  v_lshlrev_b32 v154, 16, v45
  v_and_b32 v155, 0xffff0000, v45
  s_waitcnt lgkmcnt(0)
  s_barrier
  ds_read_b128 v[212:215], v126 offset:0
  ds_read_b128 v[216:219], v126 offset:16
  ds_read_b128 v[220:223], v126 offset:32
  ds_read_b128 v[224:227], v126 offset:48
  ds_read_b64 v[228:229], v127 offset:0
  ds_read_b64 v[230:231], v127 offset:32
  ds_read_b128 v[184:187], v123 offset:10496
  ds_read_b128 v[188:191], v124 offset:14592
  ds_read_b128 v[192:195], v123 offset:18688
  s_movk_i32 s43, 4096
  s_movk_i32 s44, 8192
  s_waitcnt lgkmcnt(3)
  v_pk_add_f32 v[200:201], v[212:213], v[220:221]
  v_pk_add_f32 v[202:203], v[214:215], v[222:223]
  v_pk_add_f32 v[204:205], v[216:217], v[224:225]
  v_pk_add_f32 v[206:207], v[218:219], v[226:227]
  v_pk_add_f32 v[208:209], v[228:229], v[230:231]
  s_waitcnt lgkmcnt(0)
  buffer_store_dwordx4 v[184:187], v29, s[28:31], 0 offen sc1
  buffer_store_dwordx4 v[188:191], v29, s[28:31], s43 offen sc1
  buffer_store_dwordx4 v[192:195], v29, s[28:31], s44 offen sc1
  v_mul_f32 v200, 0x3acccccd, v200
  v_mul_f32 v202, 0x3acccccd, v202
  v_mul_f32 v204, 0x3acccccd, v204
  v_mul_f32 v206, 0x3acccccd, v206
  v_mul_f32 v208, 0x3acccccd, v208
  v_mul_f32 v201, 0x3acccccd, v201
  v_mul_f32 v203, 0x3acccccd, v203
  v_mul_f32 v205, 0x3acccccd, v205
  v_mul_f32 v207, 0x3acccccd, v207
  v_mul_f32 v209, 0x3acccccd, v209
  v_fma_f32 v201, -v200, v200, v201
  v_fma_f32 v203, -v202, v202, v203
  v_fma_f32 v205, -v204, v204, v205
  v_fma_f32 v207, -v206, v206, v207
  v_fma_f32 v209, -v208, v208, v209
  v_max_f32 v201, 0, v201
  v_max_f32 v203, 0, v203
  v_max_f32 v205, 0, v205
  v_max_f32 v207, 0, v207
  v_max_f32 v209, 0, v209
  v_cvt_pk_bf16_f32 v160, v200, v200
  v_cvt_pk_bf16_f32 v161, v202, v202
  v_cvt_pk_bf16_f32 v162, v204, v204
  v_cvt_pk_bf16_f32 v163, v206, v206
  v_cvt_pk_bf16_f32 v164, v208, v208
  v_lshlrev_b32 v160, 16, v160
  v_lshlrev_b32 v161, 16, v161
  v_lshlrev_b32 v162, 16, v162
  v_lshlrev_b32 v163, 16, v163
  v_lshlrev_b32 v164, 16, v164
  v_cvt_pk_bf16_f32 v201, v201, v201
  v_cvt_pk_bf16_f32 v203, v203, v203
  v_cvt_pk_bf16_f32 v205, v205, v205
  v_cvt_pk_bf16_f32 v207, v207, v207
  v_cvt_pk_bf16_f32 v209, v209, v209
  v_lshlrev_b32 v201, 16, v201
  v_lshlrev_b32 v203, 16, v203
  v_lshlrev_b32 v205, 16, v205
  v_lshlrev_b32 v207, 16, v207
  v_lshlrev_b32 v209, 16, v209
  v_add_f32 v201, 0x3727c5ac, v201
  v_add_f32 v203, 0x3727c5ac, v203
  v_add_f32 v205, 0x3727c5ac, v205
  v_add_f32 v207, 0x3727c5ac, v207
  v_add_f32 v209, 0x3727c5ac, v209
  v_cvt_pk_bf16_f32 v201, v201, v201
  v_cvt_pk_bf16_f32 v203, v203, v203
  v_cvt_pk_bf16_f32 v205, v205, v205
  v_cvt_pk_bf16_f32 v207, v207, v207
  v_cvt_pk_bf16_f32 v209, v209, v209
  v_lshlrev_b32 v201, 16, v201
  v_lshlrev_b32 v203, 16, v203
  v_lshlrev_b32 v205, 16, v205
  v_lshlrev_b32 v207, 16, v207
  v_lshlrev_b32 v209, 16, v209
  v_sqrt_f32 v201, v201
  v_sqrt_f32 v203, v203
  v_sqrt_f32 v205, v205
  v_sqrt_f32 v207, v207
  v_sqrt_f32 v209, v209
  v_cvt_pk_bf16_f32 v201, v201, v201
  v_cvt_pk_bf16_f32 v203, v203, v203
  v_cvt_pk_bf16_f32 v205, v205, v205
  v_cvt_pk_bf16_f32 v207, v207, v207
  v_cvt_pk_bf16_f32 v209, v209, v209
  v_lshlrev_b32 v201, 16, v201
  v_lshlrev_b32 v203, 16, v203
  v_lshlrev_b32 v205, 16, v205
  v_lshlrev_b32 v207, 16, v207
  v_lshlrev_b32 v209, 16, v209
  v_rcp_f32 v212, v201
  v_rcp_f32 v214, v203
  v_rcp_f32 v216, v205
  v_rcp_f32 v218, v207
  v_rcp_f32 v220, v209
  v_mul_f32_e64 v213, -v160, v212
  v_mul_f32_e64 v215, -v161, v214
  v_mul_f32_e64 v217, -v162, v216
  v_mul_f32_e64 v219, -v163, v218
  v_mul_f32_e64 v221, -v164, v220
  v_pk_fma_f32 v[136:137], v[136:137], v[212:213], v[212:213] op_sel:[0,0,1] op_sel_hi:[1,0,1]
  v_pk_fma_f32 v[138:139], v[138:139], v[212:213], v[212:213] op_sel:[0,0,1] op_sel_hi:[1,0,1]
  v_pk_fma_f32 v[140:141], v[140:141], v[214:215], v[214:215] op_sel:[0,0,1] op_sel_hi:[1,0,1]
  v_pk_fma_f32 v[142:143], v[142:143], v[214:215], v[214:215] op_sel:[0,0,1] op_sel_hi:[1,0,1]
  v_pk_fma_f32 v[144:145], v[144:145], v[216:217], v[216:217] op_sel:[0,0,1] op_sel_hi:[1,0,1]
  v_pk_fma_f32 v[146:147], v[146:147], v[216:217], v[216:217] op_sel:[0,0,1] op_sel_hi:[1,0,1]
  v_pk_fma_f32 v[148:149], v[148:149], v[218:219], v[218:219] op_sel:[0,0,1] op_sel_hi:[1,0,1]
  v_pk_fma_f32 v[150:151], v[150:151], v[218:219], v[218:219] op_sel:[0,0,1] op_sel_hi:[1,0,1]
  v_pk_fma_f32 v[152:153], v[152:153], v[220:221], v[220:221] op_sel:[0,0,1] op_sel_hi:[1,0,1]
  v_pk_fma_f32 v[154:155], v[154:155], v[220:221], v[220:221] op_sel:[0,0,1] op_sel_hi:[1,0,1]
  v_cvt_pk_bf16_f32 v168, v136, v137
  v_cvt_pk_bf16_f32 v169, v138, v139
  ds_write_b64 v118, v[168:169]
  v_cvt_pk_bf16_f32 v170, v140, v141
  v_cvt_pk_bf16_f32 v171, v142, v143
  ds_write_b64 v119, v[170:171]
  v_cvt_pk_bf16_f32 v172, v144, v145
  v_cvt_pk_bf16_f32 v173, v146, v147
  ds_write_b64 v120, v[172:173]
  v_cvt_pk_bf16_f32 v174, v148, v149
  v_cvt_pk_bf16_f32 v175, v150, v151
  ds_write_b64 v121, v[174:175]
  v_cvt_pk_bf16_f32 v176, v152, v153
  v_cvt_pk_bf16_f32 v177, v154, v155
  ds_write_b64 v122, v[176:177]
  s_waitcnt lgkmcnt(0)
  s_barrier
  ds_read_b128 v[212:215], v123 offset:0
  ds_read_b128 v[216:219], v124 offset:4096
  ds_read_b128 v[220:223], v123 offset:8192
  s_lshl_b32 s52, s40, 8
  s_add_u32 s52, s52, 37748736
  s_waitcnt lgkmcnt(2)
  buffer_store_dwordx4 v[212:215], v29, s[36:39], 0 offen sc1
  s_waitcnt lgkmcnt(1)
  buffer_store_dwordx4 v[216:219], v29, s[36:39], s43 offen sc1
  s_waitcnt lgkmcnt(0)
  buffer_store_dwordx4 v[220:223], v29, s[36:39], s44 offen sc1
  s_add_u32 m0, s51, 0
  s_nop 0
  buffer_load_dwordx4 v1, s[16:19], s50 offen offset:0 lds
  buffer_load_dwordx4 v1, s[16:19], s50 offen offset:1024 lds
  buffer_load_dwordx4 v1, s[16:19], s50 offen offset:2048 lds
  s_waitcnt vmcnt(3)
  s_barrier
  s_cmp_lg_u32 s45, 0
  s_cbranch_scc1 K3_nf0
  s_lshl_b32 s43, s41, 2
  s_add_u32 s43, s43, s52
  v_mov_b32 v6, 1
  v_mov_b32 v5, 0
  s_mov_b64 exec, 1
  buffer_store_dword v6, v5, s[16:19], s43 offen offset:0 sc1
  s_mov_b64 exec, -1
K3_nf0:
  buffer_load_dwordx4 a[88:91], v1, s[16:19], s62 offen offset:2048 sc1
  buffer_load_dwordx4 a[92:95], v1, s[16:19], s62 offen offset:3072 sc1
  buffer_load_dwordx4 a[96:99], v2, s[16:19], s62 offen offset:0 sc1
  s_add_u32 s62, s55, 102400
  buffer_load_dwordx4 a[100:103], v1, s[16:19], s62 offen offset:0 sc1
  buffer_load_dwordx4 a[104:107], v1, s[16:19], s62 offen offset:1024 sc1
  buffer_load_dwordx4 a[108:111], v1, s[16:19], s62 offen offset:2048 sc1
  buffer_load_dwordx4 a[112:115], v1, s[16:19], s62 offen offset:3072 sc1
  buffer_load_dwordx4 a[116:119], v2, s[16:19], s62 offen offset:0 sc1
  s_add_u32 s62, s55, 122880
  buffer_load_dwordx4 a[120:123], v1, s[16:19], s62 offen offset:0 sc1
  buffer_load_dwordx4 a[124:127], v1, s[16:19], s62 offen offset:1024 sc1
  buffer_load_dwordx4 a[128:131], v1, s[16:19], s62 offen offset:2048 sc1
  buffer_load_dwordx4 a[132:135], v1, s[16:19], s62 offen offset:3072 sc1
  buffer_load_dwordx4 a[136:139], v2, s[16:19], s62 offen offset:0 sc1
  s_add_u32 s62, s55, 143360
  buffer_load_dwordx4 a[140:143], v1, s[16:19], s62 offen offset:0 sc1
  buffer_load_dwordx4 a[144:147], v1, s[16:19], s62 offen offset:1024 sc1
  buffer_load_dwordx4 a[148:151], v1, s[16:19], s62 offen offset:2048 sc1
  buffer_load_dwordx4 a[152:155], v1, s[16:19], s62 offen offset:3072 sc1
  buffer_load_dwordx4 a[156:159], v2, s[16:19], s62 offen offset:0 sc1
  s_add_u32 s62, s55, 163840
  buffer_load_dwordx4 a[160:163], v1, s[16:19], s62 offen offset:0 sc1
  buffer_load_dwordx4 a[164:167], v1, s[16:19], s62 offen offset:1024 sc1
  buffer_load_dwordx4 a[168:171], v1, s[16:19], s62 offen offset:2048 sc1
  buffer_load_dwordx4 a[172:175], v1, s[16:19], s62 offen offset:3072 sc1
  buffer_load_dwordx4 a[176:179], v2, s[16:19], s62 offen offset:0 sc1
  s_add_u32 s62, s55, 184320
  buffer_load_dwordx4 a[180:183], v1, s[16:19], s62 offen offset:0 sc1
  v_lshlrev_b32 v5, 2, v3
  s_mov_b32 s53, 0
  v_lshlrev_b32 v32, 3, v4
  ds_read_b64 v[8:9], v32 offset:20736
  ds_read_b64 v[10:11], v32 offset:20768
  ds_read_b64 v[12:13], v32 offset:20800
  ds_read_b64 v[14:15], v32 offset:20832
  ds_read_b64 v[16:17], v32 offset:20864
  ds_read_b64 v[18:19], v32 offset:20896
  ds_read_b64 v[20:21], v32 offset:20928
  v_add_u32 v28, 21504, v1
  v_add_u32 v29, 87040, v1
  v_add_u32 v30, 152576, v1
  v_lshrrev_b32 v32, 3, v3
  v_mul_u32_u24 v31, 10240, v32
  v_lshl_add_u32 v31, v4, 7, v31
  v_and_b32 v32, 7, v3
  v_lshl_add_u32 v31, v32, 4, v31
  v_and_b32 v32, 1, v4
  v_lshlrev_b32 v32, 10, v32
  v_lshl_add_u32 v32, v3, 4, v32
  v_lshrrev_b32 v40, 1, v4
  v_lshl_add_u32 v32, v40, 8, v32
  s_waitcnt lgkmcnt(0)
  v_lshlrev_b32 v36, 16, v8
  v_and_b32 v37, 0xffff0000, v8
  v_lshlrev_b32 v38, 16, v9
  v_and_b32 v39, 0xffff0000, v9
  v_lshlrev_b32 v44, 16, v10
  v_and_b32 v45, 0xffff0000, v10
  v_lshlrev_b32 v46, 16, v11
  v_and_b32 v47, 0xffff0000, v11
  v_lshlrev_b32 v52, 16, v12
  v_and_b32 v53, 0xffff0000, v12
  v_lshlrev_b32 v54, 16, v13
  v_and_b32 v55, 0xffff0000, v13
  v_lshlrev_b32 v60, 16, v14
  v_and_b32 v61, 0xffff0000, v14
  v_lshlrev_b32 v62, 16, v15
  v_and_b32 v63, 0xffff0000, v15
  v_lshlrev_b32 v68, 16, v16
  v_and_b32 v69, 0xffff0000, v16
  v_lshlrev_b32 v70, 16, v17
  v_and_b32 v71, 0xffff0000, v17
  v_lshlrev_b32 v76, 16, v18
  v_and_b32 v77, 0xffff0000, v18
  v_lshlrev_b32 v78, 16, v19
  v_and_b32 v79, 0xffff0000, v19
  v_lshlrev_b32 v84, 16, v20
  v_and_b32 v85, 0xffff0000, v20
  v_lshlrev_b32 v86, 16, v21
  v_and_b32 v87, 0xffff0000, v21
  s_lshl_b32 s43, s40, 2
  s_add_u32 s43, s43, s45
  s_mul_i32 s56, s43, 40960
  s_add_u32 s56, s56, 16777216
  s_add_u32 s57, s56, 20480
  s_lshl_b32 s43, s40, 1
  s_add_u32 s43, s43, s47
  s_mul_i32 s58, s43, 221184
  s_lshl_b32 s43, s46, 11
  s_add_u32 s58, s58, s43
  s_add_u32 s58, s58, 29360128
  s_lshr_b32 s43, s41, 1
  s_add_u32 s43, s43, 48
  s_lshl_b32 s43, s43, 12
  s_add_u32 s59, s58, s43
  s_and_b32 s43, s41, 1
  s_lshl_b32 s43, s43, 9
  s_add_u32 s59, s59, s43
  s_mul_i32 s43, s41, 12288
  s_add_u32 s58, s58, s43
K3_p0:
  buffer_load_dword v6, v5, s[16:19], s52 offen offset:0 sc1
  s_add_u32 s53, s53, 1
  s_cmp_gt_u32 s53, 400000
  s_waitcnt vmcnt(0)
  s_cbranch_scc1 K3_x0
  v_cmp_ne_u32 vcc, 1, v6
  s_cbranch_vccnz K3_p0
K3_x0:
  buffer_load_dwordx4 v[148:151], v31, s[16:19], s56 offen offset:0 sc1
  buffer_load_dwordx4 v[152:155], v31, s[16:19], s57 offen offset:0 sc1
  buffer_load_dwordx4 v[156:159], v31, s[16:19], s56 offen offset:512 sc1
  buffer_load_dwordx4 v[160:163], v31, s[16:19], s57 offen offset:512 sc1
  buffer_load_dwordx4 v[164:167], v31, s[16:19], s56 offen offset:1024 sc1
  buffer_load_dwordx4 v[168:171], v31, s[16:19], s57 offen offset:1024 sc1
  buffer_load_dwordx4 v[172:175], v31, s[16:19], s56 offen offset:1536 sc1
  buffer_load_dwordx4 v[176:179], v31, s[16:19], s57 offen offset:1536 sc1
  buffer_load_dwordx4 v[180:183], v31, s[16:19], s56 offen offset:2048 sc1
  buffer_load_dwordx4 v[184:187], v31, s[16:19], s57 offen offset:2048 sc1
  buffer_load_dwordx4 v[188:191], v31, s[16:19], s56 offen offset:2560 sc1
  buffer_load_dwordx4 v[192:195], v31, s[16:19], s57 offen offset:2560 sc1
  buffer_load_dwordx4 v[196:199], v31, s[16:19], s56 offen offset:3072 sc1
  buffer_load_dwordx4 v[200:203], v31, s[16:19], s57 offen offset:3072 sc1
  buffer_load_dwordx4 v[204:207], v31, s[16:19], s56 offen offset:3584 sc1
  buffer_load_dwordx4 v[208:211], v31, s[16:19], s57 offen offset:3584 sc1
  s_barrier
  ds_read_b128 v[92:95], v28 offset:0
  ds_read_b128 v[96:99], v28 offset:1024
  ds_read_b128 v[100:103], v28 offset:2048
  ds_read_b128 v[104:107], v28 offset:3072
  ds_read_b128 v[108:111], v28 offset:4096
  ds_read_b128 v[112:115], v28 offset:5120
  ds_read_b128 v[116:119], v28 offset:6144
  s_waitcnt vmcnt(14)
  s_waitcnt lgkmcnt(6)
  v_mfma_f32_16x16x32_bf16 v[40:43], v[92:95], v[152:155], v[36:39]
  ds_read_b128 v[120:123], v28 offset:7168
  v_mfma_f32_16x16x32_bf16 v[36:39], v[92:95], v[148:151], v[36:39]
  s_waitcnt lgkmcnt(6)
  v_mfma_f32_16x16x32_bf16 v[48:51], v[96:99], v[152:155], v[44:47]
  ds_read_b128 v[124:127], v28 offset:8192
  v_mfma_f32_16x16x32_bf16 v[44:47], v[96:99], v[148:151], v[44:47]
  s_add_u32 s56, s56, 4096
  s_add_u32 s57, s57, 4096
  buffer_load_dwordx4 v[212:215], v31, s[16:19], s56 offen offset:0 sc1
  s_waitcnt lgkmcnt(6)
  v_mfma_f32_16x16x32_bf16 v[56:59], v[100:103], v[152:155], v[52:55]
  ds_read_b128 v[128:131], v28 offset:9216
  v_mfma_f32_16x16x32_bf16 v[52:55], v[100:103], v[148:151], v[52:55]
  s_waitcnt lgkmcnt(6)
  v_mfma_f32_16x16x32_bf16 v[64:67], v[104:107], v[152:155], v[60:63]
  ds_read_b128 v[132:135], v28 offset:10240
  v_mfma_f32_16x16x32_bf16 v[60:63], v[104:107], v[148:151], v[60:63]
  buffer_load_dwordx4 v[216:219], v31, s[16:19], s57 offen offset:0 sc1
  s_waitcnt lgkmcnt(6)
  v_mfma_f32_16x16x32_bf16 v[72:75], v[108:111], v[152:155], v[68:71]
  ds_read_b128 v[136:139], v28 offset:11264
  v_mfma_f32_16x16x32_bf16 v[68:71], v[108:111], v[148:151], v[68:71]
  s_waitcnt lgkmcnt(6)
  v_mfma_f32_16x16x32_bf16 v[80:83], v[112:115], v[152:155], v[76:79]
  ds_read_b128 v[140:143], v28 offset:12288
  v_mfma_f32_16x16x32_bf16 v[76:79], v[112:115], v[148:151], v[76:79]
  buffer_load_dwordx4 v[220:223], v31, s[16:19], s56 offen offset:512 sc1
  s_waitcnt lgkmcnt(6)
  v_mfma_f32_16x16x32_bf16 v[88:91], v[116:119], v[152:155], v[84:87]
  ds_read_b128 v[144:147], v28 offset:13312
  v_mfma_f32_16x16x32_bf16 v[84:87], v[116:119], v[148:151], v[84:87]
  s_waitcnt vmcnt(15)
  s_waitcnt lgkmcnt(6)
  v_mfma_f32_16x16x32_bf16 v[40:43], v[120:123], v[160:163], v[40:43]
  ds_read_b128 v[92:95], v28 offset:14336
  v_mfma_f32_16x16x32_bf16 v[36:39], v[120:123], v[156:159], v[36:39]
  s_waitcnt lgkmcnt(6)
  v_mfma_f32_16x16x32_bf16 v[48:51], v[124:127], v[160:163], v[48:51]
  ds_read_b128 v[96:99], v28 offset:15360
  v_mfma_f32_16x16x32_bf16 v[44:47], v[124:127], v[156:159], v[44:47]
  buffer_load_dwordx4 v[224:227], v31, s[16:19], s57 offen offset:512 sc1
  s_waitcnt lgkmcnt(6)
  v_mfma_f32_16x16x32_bf16 v[56:59], v[128:131], v[160:163], v[56:59]
  ds_read_b128 v[100:103], v28 offset:16384
  v_mfma_f32_16x16x32_bf16 v[52:55], v[128:131], v[156:159], v[52:55]
  s_waitcnt lgkmcnt(6)
  v_mfma_f32_16x16x32_bf16 v[64:67], v[132:135], v[160:163], v[64:67]
  ds_read_b128 v[104:107], v28 offset:17408
  v_mfma_f32_16x16x32_bf16 v[60:63], v[132:135], v[156:159], v[60:63]
  buffer_load_dwordx4 v[228:231], v31, s[16:19], s56 offen offset:1024 sc1
  s_waitcnt lgkmcnt(6)
  v_mfma_f32_16x16x32_bf16 v[72:75], v[136:139], v[160:163], v[72:75]
  ds_read_b128 v[108:111], v28 offset:18432
  v_mfma_f32_16x16x32_bf16 v[68:71], v[136:139], v[156:159], v[68:71]
  s_waitcnt lgkmcnt(6)
  v_mfma_f32_16x16x32_bf16 v[80:83], v[140:143], v[160:163], v[80:83]
  ds_read_b128 v[112:115], v28 offset:19456
  v_mfma_f32_16x16x32_bf16 v[76:79], v[140:143], v[156:159], v[76:79]
  buffer_load_dwordx4 v[232:235], v31, s[16:19], s57 offen offset:1024 sc1
  s_waitcnt lgkmcnt(6)
  v_mfma_f32_16x16x32_bf16 v[88:91], v[144:147], v[160:163], v[88:91]
  ds_read_b128 v[116:119], v28 offset:20480
  v_mfma_f32_16x16x32_bf16 v[84:87], v[144:147], v[156:159], v[84:87]
  s_waitcnt vmcnt(16)
  s_waitcnt lgkmcnt(6)
  v_mfma_f32_16x16x32_bf16 v[40:43], v[92:95], v[168:171], v[40:43]
  ds_read_b128 v[120:123], v28 offset:21504
  v_mfma_f32_16x16x32_bf16 v[36:39], v[92:95], v[164:167], v[36:39]
  s_waitcnt lgkmcnt(6)
  v_mfma_f32_16x16x32_bf16 v[48:51], v[96:99], v[168:171], v[48:51]
  ds_read_b128 v[124:127], v28 offset:22528
  v_mfma_f32_16x16x32_bf16 v[44:47], v[96:99], v[164:167], v[44:47]
  buffer_load_dwordx4 v[236:239], v31, s[16:19], s56 offen offset:1536 sc1
  s_waitcnt lgkmcnt(6)
  v_mfma_f32_16x16x32_bf16 v[56:59], v[100:103], v[168:171], v[56:59]
  ds_read_b128 v[128:131], v28 offset:23552
  v_mfma_f32_16x16x32_bf16 v[52:55], v[100:103], v[164:167], v[52:55]
  s_waitcnt lgkmcnt(6)
  v_mfma_f32_16x16x32_bf16 v[64:67], v[104:107], v[168:171], v[64:67]
  ds_read_b128 v[132:135], v28 offset:24576
  v_mfma_f32_16x16x32_bf16 v[60:63], v[104:107], v[164:167], v[60:63]
  buffer_load_dwordx4 v[240:243], v31, s[16:19], s57 offen offset:1536 sc1
  s_waitcnt lgkmcnt(6)
  v_mfma_f32_16x16x32_bf16 v[72:75], v[108:111], v[168:171], v[72:75]
  ds_read_b128 v[136:139], v28 offset:25600
  v_mfma_f32_16x16x32_bf16 v[68:71], v[108:111], v[164:167], v[68:71]
  s_waitcnt lgkmcnt(6)
  v_mfma_f32_16x16x32_bf16 v[80:83], v[112:115], v[168:171], v[80:83]
  ds_read_b128 v[140:143], v28 offset:26624
  v_mfma_f32_16x16x32_bf16 v[76:79], v[112:115], v[164:167], v[76:79]
  buffer_load_dwordx4 v[148:151], v31, s[16:19], s56 offen offset:2048 sc1
  s_waitcnt lgkmcnt(6)
  v_mfma_f32_16x16x32_bf16 v[88:91], v[116:119], v[168:171], v[88:91]
  ds_read_b128 v[144:147], v28 offset:27648
  v_mfma_f32_16x16x32_bf16 v[84:87], v[116:119], v[164:167], v[84:87]
  s_waitcnt vmcnt(17)
  s_waitcnt lgkmcnt(6)
  v_mfma_f32_16x16x32_bf16 v[40:43], v[120:123], v[176:179], v[40:43]
  ds_read_b128 v[92:95], v28 offset:28672
  v_mfma_f32_16x16x32_bf16 v[36:39], v[120:123], v[172:175], v[36:39]
  s_waitcnt lgkmcnt(6)
  v_mfma_f32_16x16x32_bf16 v[48:51], v[124:127], v[176:179], v[48:51]
  ds_read_b128 v[96:99], v28 offset:29696
  v_mfma_f32_16x16x32_bf16 v[44:47], v[124:127], v[172:175], v[44:47]
  buffer_load_dwordx4 v[152:155], v31, s[16:19], s57 offen offset:2048 sc1
  s_waitcnt lgkmcnt(6)
  v_mfma_f32_16x16x32_bf16 v[56:59], v[128:131], v[176:179], v[56:59]
  ds_read_b128 v[100:103], v28 offset:30720
  v_mfma_f32_16x16x32_bf16 v[52:55], v[128:131], v[172:175], v[52:55]
  s_waitcnt lgkmcnt(6)
  v_mfma_f32_16x16x32_bf16 v[64:67], v[132:135], v[176:179], v[64:67]
  ds_read_b128 v[104:107], v28 offset:31744
  v_mfma_f32_16x16x32_bf16 v[60:63], v[132:135], v[172:175], v[60:63]
  buffer_load_dwordx4 v[156:159], v31, s[16:19], s56 offen offset:2560 sc1
  s_waitcnt lgkmcnt(6)
  v_mfma_f32_16x16x32_bf16 v[72:75], v[136:139], v[176:179], v[72:75]
  ds_read_b128 v[108:111], v28 offset:32768
  v_mfma_f32_16x16x32_bf16 v[68:71], v[136:139], v[172:175], v[68:71]
  s_waitcnt lgkmcnt(6)
  v_mfma_f32_16x16x32_bf16 v[80:83], v[140:143], v[176:179], v[80:83]
  ds_read_b128 v[112:115], v28 offset:33792
  v_mfma_f32_16x16x32_bf16 v[76:79], v[140:143], v[172:175], v[76:79]
  buffer_load_dwordx4 v[160:163], v31, s[16:19], s57 offen offset:2560 sc1
  s_waitcnt lgkmcnt(6)
  v_mfma_f32_16x16x32_bf16 v[88:91], v[144:147], v[176:179], v[88:91]
  ds_read_b128 v[116:119], v28 offset:34816
  v_mfma_f32_16x16x32_bf16 v[84:87], v[144:147], v[172:175], v[84:87]
  s_waitcnt vmcnt(18)
  s_waitcnt lgkmcnt(6)
  v_mfma_f32_16x16x32_bf16 v[40:43], v[92:95], v[184:187], v[40:43]
  ds_read_b128 v[120:123], v28 offset:35840
  v_mfma_f32_16x16x32_bf16 v[36:39], v[92:95], v[180:183], v[36:39]
  s_waitcnt lgkmcnt(6)
  v_mfma_f32_16x16x32_bf16 v[48:51], v[96:99], v[184:187], v[48:51]
  ds_read_b128 v[124:127], v28 offset:36864
  v_mfma_f32_16x16x32_bf16 v[44:47], v[96:99], v[180:183], v[44:47]
  buffer_load_dwordx4 v[164:167], v31, s[16:19], s56 offen offset:3072 sc1
  s_waitcnt lgkmcnt(6)
  v_mfma_f32_16x16x32_bf16 v[56:59], v[100:103], v[184:187], v[56:59]
  ds_read_b128 v[128:131], v28 offset:37888
  v_mfma_f32_16x16x32_bf16 v[52:55], v[100:103], v[180:183], v[52:55]
  s_waitcnt lgkmcnt(6)
  v_mfma_f32_16x16x32_bf16 v[64:67], v[104:107], v[184:187], v[64:67]
  ds_read_b128 v[132:135], v28 offset:38912
  v_mfma_f32_16x16x32_bf16 v[60:63], v[104:107], v[180:183], v[60:63]
  buffer_load_dwordx4 v[168:171], v31, s[16:19], s57 offen offset:3072 sc1
  s_waitcnt lgkmcnt(6)
  v_mfma_f32_16x16x32_bf16 v[72:75], v[108:111], v[184:187], v[72:75]
  ds_read_b128 v[136:139], v28 offset:39936
  v_mfma_f32_16x16x32_bf16 v[68:71], v[108:111], v[180:183], v[68:71]
  s_waitcnt lgkmcnt(6)
  v_mfma_f32_16x16x32_bf16 v[80:83], v[112:115], v[184:187], v[80:83]
  ds_read_b128 v[140:143], v28 offset:40960
  v_mfma_f32_16x16x32_bf16 v[76:79], v[112:115], v[180:183], v[76:79]
  buffer_load_dwordx4 v[172:175], v31, s[16:19], s56 offen offset:3584 sc1
  s_waitcnt lgkmcnt(6)
  v_mfma_f32_16x16x32_bf16 v[88:91], v[116:119], v[184:187], v[88:91]
  ds_read_b128 v[144:147], v28 offset:41984
  v_mfma_f32_16x16x32_bf16 v[84:87], v[116:119], v[180:183], v[84:87]
  s_waitcnt vmcnt(19)
  s_waitcnt lgkmcnt(6)
  v_mfma_f32_16x16x32_bf16 v[40:43], v[120:123], v[192:195], v[40:43]
  ds_read_b128 v[92:95], v28 offset:43008
  v_mfma_f32_16x16x32_bf16 v[36:39], v[120:123], v[188:191], v[36:39]
  s_waitcnt lgkmcnt(6)
  v_mfma_f32_16x16x32_bf16 v[48:51], v[124:127], v[192:195], v[48:51]
  ds_read_b128 v[96:99], v28 offset:44032
  v_mfma_f32_16x16x32_bf16 v[44:47], v[124:127], v[188:191], v[44:47]
  buffer_load_dwordx4 v[176:179], v31, s[16:19], s57 offen offset:3584 sc1
  s_waitcnt lgkmcnt(6)
  v_mfma_f32_16x16x32_bf16 v[56:59], v[128:131], v[192:195], v[56:59]
  ds_read_b128 v[100:103], v28 offset:45056
  v_mfma_f32_16x16x32_bf16 v[52:55], v[128:131], v[188:191], v[52:55]
  s_waitcnt lgkmcnt(6)
  v_mfma_f32_16x16x32_bf16 v[64:67], v[132:135], v[192:195], v[64:67]
  ds_read_b128 v[104:107], v28 offset:46080
  v_mfma_f32_16x16x32_bf16 v[60:63], v[132:135], v[188:191], v[60:63]
  s_add_u32 s56, s56, 4096
  s_add_u32 s57, s57, 4096
  buffer_load_dwordx4 v[180:183], v31, s[16:19], s56 offen offset:0 sc1
  s_waitcnt lgkmcnt(6)
  v_mfma_f32_16x16x32_bf16 v[72:75], v[136:139], v[192:195], v[72:75]
  ds_read_b128 v[108:111], v28 offset:47104
  v_mfma_f32_16x16x32_bf16 v[68:71], v[136:139], v[188:191], v[68:71]
  s_waitcnt lgkmcnt(6)
  v_mfma_f32_16x16x32_bf16 v[80:83], v[140:143], v[192:195], v[80:83]
  ds_read_b128 v[112:115], v28 offset:48128
  v_mfma_f32_16x16x32_bf16 v[76:79], v[140:143], v[188:191], v[76:79]
  buffer_load_dwordx4 v[184:187], v31, s[16:19], s57 offen offset:0 sc1
  s_waitcnt lgkmcnt(6)
  v_mfma_f32_16x16x32_bf16 v[88:91], v[144:147], v[192:195], v[88:91]
  ds_read_b128 v[116:119], v28 offset:49152
  v_mfma_f32_16x16x32_bf16 v[84:87], v[144:147], v[188:191], v[84:87]
  s_waitcnt vmcnt(20)
  s_waitcnt lgkmcnt(6)
  v_mfma_f32_16x16x32_bf16 v[40:43], v[92:95], v[200:203], v[40:43]
  ds_read_b128 v[120:123], v28 offset:50176
  v_mfma_f32_16x16x32_bf16 v[36:39], v[92:95], v[196:199], v[36:39]
  s_waitcnt lgkmcnt(6)
  v_mfma_f32_16x16x32_bf16 v[48:51], v[96:99], v[200:203], v[48:51]
  ds_read_b128 v[124:127], v28 offset:51200
  v_mfma_f32_16x16x32_bf16 v[44:47], v[96:99], v[196:199], v[44:47]
  buffer_load_dwordx4 v[188:191], v31, s[16:19], s56 offen offset:512 sc1
  s_waitcnt lgkmcnt(6)
  v_mfma_f32_16x16x32_bf16 v[56:59], v[100:103], v[200:203], v[56:59]
  ds_read_b128 v[128:131], v28 offset:52224
  v_mfma_f32_16x16x32_bf16 v[52:55], v[100:103], v[196:199], v[52:55]
  s_waitcnt lgkmcnt(6)
  v_mfma_f32_16x16x32_bf16 v[64:67], v[104:107], v[200:203], v[64:67]
  ds_read_b128 v[132:135], v28 offset:53248
  v_mfma_f32_16x16x32_bf16 v[60:63], v[104:107], v[196:199], v[60:63]
  buffer_load_dwordx4 v[192:195], v31, s[16:19], s57 offen offset:512 sc1
  s_waitcnt lgkmcnt(6)
  v_mfma_f32_16x16x32_bf16 v[72:75], v[108:111], v[200:203], v[72:75]
  ds_read_b128 v[136:139], v28 offset:54272
  v_mfma_f32_16x16x32_bf16 v[68:71], v[108:111], v[196:199], v[68:71]
  s_waitcnt lgkmcnt(6)
  v_mfma_f32_16x16x32_bf16 v[80:83], v[112:115], v[200:203], v[80:83]
  ds_read_b128 v[140:143], v28 offset:55296
  v_mfma_f32_16x16x32_bf16 v[76:79], v[112:115], v[196:199], v[76:79]
  s_waitcnt lgkmcnt(6)
  v_mfma_f32_16x16x32_bf16 v[88:91], v[116:119], v[200:203], v[88:91]
  ds_read_b128 v[144:147], v28 offset:56320
  v_mfma_f32_16x16x32_bf16 v[84:87], v[116:119], v[196:199], v[84:87]
  s_waitcnt vmcnt(20)
  s_waitcnt lgkmcnt(6)
  v_mfma_f32_16x16x32_bf16 v[40:43], v[120:123], v[208:211], v[40:43]
  ds_read_b128 v[92:95], v28 offset:57344
  v_mfma_f32_16x16x32_bf16 v[36:39], v[120:123], v[204:207], v[36:39]
  s_waitcnt lgkmcnt(6)
  v_mfma_f32_16x16x32_bf16 v[48:51], v[124:127], v[208:211], v[48:51]
  ds_read_b128 v[96:99], v28 offset:58368
  v_mfma_f32_16x16x32_bf16 v[44:47], v[124:127], v[204:207], v[44:47]
  buffer_load_dwordx4 v[196:199], v31, s[16:19], s56 offen offset:1024 sc1
  s_waitcnt lgkmcnt(6)
  v_mfma_f32_16x16x32_bf16 v[56:59], v[128:131], v[208:211], v[56:59]
  ds_read_b128 v[100:103], v28 offset:59392
  v_mfma_f32_16x16x32_bf16 v[52:55], v[128:131], v[204:207], v[52:55]
  s_waitcnt lgkmcnt(6)
  v_mfma_f32_16x16x32_bf16 v[64:67], v[132:135], v[208:211], v[64:67]
  ds_read_b128 v[104:107], v28 offset:60416
  v_mfma_f32_16x16x32_bf16 v[60:63], v[132:135], v[204:207], v[60:63]
  buffer_load_dwordx4 v[200:203], v31, s[16:19], s57 offen offset:1024 sc1
  s_waitcnt lgkmcnt(6)
  v_mfma_f32_16x16x32_bf16 v[72:75], v[136:139], v[208:211], v[72:75]
  ds_read_b128 v[108:111], v28 offset:61440
  v_mfma_f32_16x16x32_bf16 v[68:71], v[136:139], v[204:207], v[68:71]
  s_waitcnt lgkmcnt(6)
  v_mfma_f32_16x16x32_bf16 v[80:83], v[140:143], v[208:211], v[80:83]
  ds_read_b128 v[112:115], v28 offset:62464
  v_mfma_f32_16x16x32_bf16 v[76:79], v[140:143], v[204:207], v[76:79]
  s_waitcnt lgkmcnt(6)
  v_mfma_f32_16x16x32_bf16 v[88:91], v[144:147], v[208:211], v[88:91]
  ds_read_b128 v[116:119], v28 offset:63488
  v_mfma_f32_16x16x32_bf16 v[84:87], v[144:147], v[204:207], v[84:87]
  s_waitcnt vmcnt(20)
  s_waitcnt lgkmcnt(6)
  v_mfma_f32_16x16x32_bf16 v[40:43], v[92:95], v[216:219], v[40:43]
  ds_read_b128 v[120:123], v28 offset:64512
  v_mfma_f32_16x16x32_bf16 v[36:39], v[92:95], v[212:215], v[36:39]
  s_waitcnt lgkmcnt(6)
  v_mfma_f32_16x16x32_bf16 v[48:51], v[96:99], v[216:219], v[48:51]
  ds_read_b128 v[124:127], v29 offset:0
  v_mfma_f32_16x16x32_bf16 v[44:47], v[96:99], v[212:215], v[44:47]
  buffer_load_dwordx4 v[204:207], v31, s[16:19], s56 offen offset:1536 sc1
  s_waitcnt lgkmcnt(6)
  v_mfma_f32_16x16x32_bf16 v[56:59], v[100:103], v[216:219], v[56:59]
  ds_read_b128 v[128:131], v29 offset:1024
  v_mfma_f32_16x16x32_bf16 v[52:55], v[100:103], v[212:215], v[52:55]
  s_waitcnt lgkmcnt(6)
  v_mfma_f32_16x16x32_bf16 v[64:67], v[104:107], v[216:219], v[64:67]
  ds_read_b128 v[132:135], v29 offset:2048
  v_mfma_f32_16x16x32_bf16 v[60:63], v[104:107], v[212:215], v[60:63]
  buffer_load_dwordx4 v[208:211], v31, s[16:19], s57 offen offset:1536 sc1
  s_waitcnt lgkmcnt(6)
  v_mfma_f32_16x16x32_bf16 v[72:75], v[108:111], v[216:219], v[72:75]
  ds_read_b128 v[136:139], v29 offset:3072
  v_mfma_f32_16x16x32_bf16 v[68:71], v[108:111], v[212:215], v[68:71]
  s_waitcnt lgkmcnt(6)
  v_mfma_f32_16x16x32_bf16 v[80:83], v[112:115], v[216:219], v[80:83]
  ds_read_b128 v[140:143], v29 offset:4096
  v_mfma_f32_16x16x32_bf16 v[76:79], v[112:115], v[212:215], v[76:79]
  s_waitcnt lgkmcnt(6)
  v_mfma_f32_16x16x32_bf16 v[88:91], v[116:119], v[216:219], v[88:91]
  ds_read_b128 v[144:147], v29 offset:5120
  v_mfma_f32_16x16x32_bf16 v[84:87], v[116:119], v[212:215], v[84:87]
  s_waitcnt vmcnt(20)
  s_waitcnt lgkmcnt(6)
  v_mfma_f32_16x16x32_bf16 v[40:43], v[120:123], v[224:227], v[40:43]
  ds_read_b128 v[92:95], v29 offset:6144
  v_mfma_f32_16x16x32_bf16 v[36:39], v[120:123], v[220:223], v[36:39]
  s_waitcnt lgkmcnt(6)
  v_mfma_f32_16x16x32_bf16 v[48:51], v[124:127], v[224:227], v[48:51]
  ds_read_b128 v[96:99], v29 offset:7168
  v_mfma_f32_16x16x32_bf16 v[44:47], v[124:127], v[220:223], v[44:47]
  s_waitcnt lgkmcnt(6)
  v_mfma_f32_16x16x32_bf16 v[56:59], v[128:131], v[224:227], v[56:59]
  ds_read_b128 v[100:103], v29 offset:8192
  v_mfma_f32_16x16x32_bf16 v[52:55], v[128:131], v[220:223], v[52:55]
  s_waitcnt lgkmcnt(6)
  v_mfma_f32_16x16x32_bf16 v[64:67], v[132:135], v[224:227], v[64:67]
  ds_read_b128 v[104:107], v29 offset:9216
  v_mfma_f32_16x16x32_bf16 v[60:63], v[132:135], v[220:223], v[60:63]
  s_waitcnt lgkmcnt(6)
  v_mfma_f32_16x16x32_bf16 v[72:75], v[136:139], v[224:227], v[72:75]
  ds_read_b128 v[108:111], v29 offset:10240
  v_mfma_f32_16x16x32_bf16 v[68:71], v[136:139], v[220:223], v[68:71]
  s_waitcnt lgkmcnt(6)
  v_mfma_f32_16x16x32_bf16 v[80:83], v[140:143], v[224:227], v[80:83]
  ds_read_b128 v[112:115], v29 offset:11264
  v_mfma_f32_16x16x32_bf16 v[76:79], v[140:143], v[220:223], v[76:79]
  s_waitcnt lgkmcnt(6)
  v_mfma_f32_16x16x32_bf16 v[88:91], v[144:147], v[224:227], v[88:91]
  ds_read_b128 v[116:119], v29 offset:12288
  v_mfma_f32_16x16x32_bf16 v[84:87], v[144:147], v[220:223], v[84:87]
  s_waitcnt vmcnt(18)
  s_waitcnt lgkmcnt(6)
  v_mfma_f32_16x16x32_bf16 v[40:43], v[92:95], v[232:235], v[40:43]
  ds_read_b128 v[120:123], v29 offset:13312
  v_mfma_f32_16x16x32_bf16 v[36:39], v[92:95], v[228:231], v[36:39]
  s_waitcnt lgkmcnt(6)
  v_mfma_f32_16x16x32_bf16 v[48:51], v[96:99], v[232:235], v[48:51]
  ds_read_b128 v[124:127], v29 offset:14336
  v_mfma_f32_16x16x32_bf16 v[44:47], v[96:99], v[228:231], v[44:47]
  s_waitcnt lgkmcnt(6)
  v_mfma_f32_16x16x32_bf16 v[56:59], v[100:103], v[232:235], v[56:59]
  ds_read_b128 v[128:131], v29 offset:15360
  v_mfma_f32_16x16x32_bf16 v[52:55], v[100:103], v[228:231], v[52:55]
  s_waitcnt lgkmcnt(6)
  v_mfma_f32_16x16x32_bf16 v[64:67], v[104:107], v[232:235], v[64:67]
  ds_read_b128 v[132:135], v29 offset:16384
  v_mfma_f32_16x16x32_bf16 v[60:63], v[104:107], v[228:231], v[60:63]
  s_waitcnt lgkmcnt(6)
  v_mfma_f32_16x16x32_bf16 v[72:75], v[108:111], v[232:235], v[72:75]
  ds_read_b128 v[136:139], v29 offset:17408
  v_mfma_f32_16x16x32_bf16 v[68:71], v[108:111], v[228:231], v[68:71]
  s_waitcnt lgkmcnt(6)
  v_mfma_f32_16x16x32_bf16 v[80:83], v[112:115], v[232:235], v[80:83]
  ds_read_b128 v[140:143], v29 offset:18432
  v_mfma_f32_16x16x32_bf16 v[76:79], v[112:115], v[228:231], v[76:79]
  s_waitcnt lgkmcnt(6)
  v_mfma_f32_16x16x32_bf16 v[88:91], v[116:119], v[232:235], v[88:91]
  ds_read_b128 v[144:147], v29 offset:19456
  v_mfma_f32_16x16x32_bf16 v[84:87], v[116:119], v[228:231], v[84:87]
  s_waitcnt vmcnt(16)
  s_waitcnt lgkmcnt(6)
  v_mfma_f32_16x16x32_bf16 v[40:43], v[120:123], v[240:243], v[40:43]
  ds_read_b128 v[92:95], v29 offset:26624
  v_mfma_f32_16x16x32_bf16 v[36:39], v[120:123], v[236:239], v[36:39]
  s_waitcnt lgkmcnt(6)
  v_mfma_f32_16x16x32_bf16 v[48:51], v[124:127], v[240:243], v[48:51]
  ds_read_b128 v[96:99], v29 offset:33792
  v_mfma_f32_16x16x32_bf16 v[44:47], v[124:127], v[236:239], v[44:47]
  s_waitcnt lgkmcnt(6)
  v_mfma_f32_16x16x32_bf16 v[56:59], v[128:131], v[240:243], v[56:59]
  ds_read_b128 v[100:103], v29 offset:40960
  v_mfma_f32_16x16x32_bf16 v[52:55], v[128:131], v[236:239], v[52:55]
  s_waitcnt lgkmcnt(6)
  v_mfma_f32_16x16x32_bf16 v[64:67], v[132:135], v[240:243], v[64:67]
  ds_read_b128 v[104:107], v29 offset:48128
  v_mfma_f32_16x16x32_bf16 v[60:63], v[132:135], v[236:239], v[60:63]
  s_waitcnt lgkmcnt(6)
  v_mfma_f32_16x16x32_bf16 v[72:75], v[136:139], v[240:243], v[72:75]
  ds_read_b128 v[108:111], v29 offset:55296
  v_mfma_f32_16x16x32_bf16 v[68:71], v[136:139], v[236:239], v[68:71]
  s_waitcnt lgkmcnt(6)
  v_mfma_f32_16x16x32_bf16 v[80:83], v[140:143], v[240:243], v[80:83]
  ds_read_b128 v[112:115], v29 offset:62464
  v_mfma_f32_16x16x32_bf16 v[76:79], v[140:143], v[236:239], v[76:79]
  s_waitcnt lgkmcnt(6)
  v_mfma_f32_16x16x32_bf16 v[88:91], v[144:147], v[240:243], v[88:91]
  ds_read_b128 v[116:119], v30 offset:4096
  v_mfma_f32_16x16x32_bf16 v[84:87], v[144:147], v[236:239], v[84:87]
  s_waitcnt vmcnt(14)
  s_waitcnt lgkmcnt(6)
  v_mfma_f32_16x16x32_bf16 v[88:91], v[92:95], v[152:155], v[88:91]
  v_mfma_f32_16x16x32_bf16 v[84:87], v[92:95], v[148:151], v[84:87]
  s_waitcnt vmcnt(12)
  s_waitcnt lgkmcnt(5)
  v_mfma_f32_16x16x32_bf16 v[88:91], v[96:99], v[160:163], v[88:91]
  ds_read_b128 v[124:127], v29 offset:20480
  v_mfma_f32_16x16x32_bf16 v[84:87], v[96:99], v[156:159], v[84:87]
  s_waitcnt vmcnt(10)
  s_waitcnt lgkmcnt(5)
  v_mfma_f32_16x16x32_bf16 v[88:91], v[100:103], v[168:171], v[88:91]
  ds_read_b128 v[128:131], v29 offset:27648
  v_mfma_f32_16x16x32_bf16 v[84:87], v[100:103], v[164:167], v[84:87]
  s_waitcnt vmcnt(8)
  s_waitcnt lgkmcnt(5)
  v_mfma_f32_16x16x32_bf16 v[88:91], v[104:107], v[176:179], v[88:91]
  ds_read_b128 v[132:135], v29 offset:34816
  v_mfma_f32_16x16x32_bf16 v[84:87], v[104:107], v[172:175], v[84:87]
  s_waitcnt vmcnt(6)
  s_waitcnt lgkmcnt(5)
  v_mfma_f32_16x16x32_bf16 v[88:91], v[108:111], v[184:187], v[88:91]
  ds_read_b128 v[136:139], v29 offset:41984
  v_mfma_f32_16x16x32_bf16 v[84:87], v[108:111], v[180:183], v[84:87]
  s_waitcnt vmcnt(4)
  s_waitcnt lgkmcnt(5)
  v_mfma_f32_16x16x32_bf16 v[88:91], v[112:115], v[192:195], v[88:91]
  ds_read_b128 v[140:143], v29 offset:49152
  v_mfma_f32_16x16x32_bf16 v[84:87], v[112:115], v[188:191], v[84:87]
  s_waitcnt vmcnt(2)
  s_waitcnt lgkmcnt(5)
  v_mfma_f32_16x16x32_bf16 v[88:91], v[116:119], v[200:203], v[88:91]
  ds_read_b128 v[144:147], v29 offset:56320
  v_mfma_f32_16x16x32_bf16 v[84:87], v[116:119], v[196:199], v[84:87]
  s_waitcnt vmcnt(0)
  v_mfma_f32_16x16x32_bf16 v[88:91], v[24:27], v[208:211], v[88:91]
  ds_read_b128 v[92:95], v29 offset:63488
  v_mfma_f32_16x16x32_bf16 v[84:87], v[24:27], v[204:207], v[84:87]
  s_waitcnt lgkmcnt(6)
  v_mfma_f32_16x16x32_bf16 v[40:43], v[124:127], v[152:155], v[40:43]
  ds_read_b128 v[96:99], v30 offset:5120
  v_mfma_f32_16x16x32_bf16 v[36:39], v[124:127], v[148:151], v[36:39]
  s_waitcnt lgkmcnt(6)
  v_mfma_f32_16x16x32_bf16 v[40:43], v[128:131], v[160:163], v[40:43]
  s_nop 1
  v_mul_f32_e64 v84, v84, |v84|
  ds_read_b128 v[100:103], v29 offset:21504
  v_mfma_f32_16x16x32_bf16 v[36:39], v[128:131], v[156:159], v[36:39]
  v_mul_f32_e64 v85, v85, |v85|
  s_waitcnt lgkmcnt(6)
  v_mfma_f32_16x16x32_bf16 v[40:43], v[132:135], v[168:171], v[40:43]
  v_mul_f32_e64 v86, v86, |v86|
  ds_read_b128 v[104:107], v29 offset:28672
  v_mfma_f32_16x16x32_bf16 v[36:39], v[132:135], v[164:167], v[36:39]
  v_mul_f32_e64 v87, v87, |v87|
  s_waitcnt lgkmcnt(6)
  v_mfma_f32_16x16x32_bf16 v[40:43], v[136:139], v[176:179], v[40:43]
  v_cvt_pk_bf16_f32 v16, v84, v85
  ds_read_b128 v[108:111], v29 offset:35840
  v_mfma_f32_16x16x32_bf16 v[36:39], v[136:139], v[172:175], v[36:39]
  v_cvt_pk_bf16_f32 v17, v86, v87
  s_waitcnt lgkmcnt(6)
  v_mfma_f32_16x16x32_bf16 v[40:43], v[140:143], v[184:187], v[40:43]
  v_pk_max_i16 v16, v16, 0
  ds_read_b128 v[112:115], v29 offset:43008
  v_mfma_f32_16x16x32_bf16 v[36:39], v[140:143], v[180:183], v[36:39]
  v_pk_max_i16 v17, v17, 0
  s_waitcnt lgkmcnt(6)
  v_mfma_f32_16x16x32_bf16 v[40:43], v[144:147], v[192:195], v[40:43]
  v_mul_f32_e64 v88, v88, |v88|
  ds_read_b128 v[116:119], v29 offset:50176
  v_mfma_f32_16x16x32_bf16 v[36:39], v[144:147], v[188:191], v[36:39]
  v_mul_f32_e64 v89, v89, |v89|
  s_waitcnt lgkmcnt(6)
  v_mfma_f32_16x16x32_bf16 v[40:43], v[92:95], v[200:203], v[40:43]
  v_mul_f32_e64 v90, v90, |v90|
  ds_read_b128 v[120:123], v29 offset:57344
  v_mfma_f32_16x16x32_bf16 v[36:39], v[92:95], v[196:199], v[36:39]
  v_mul_f32_e64 v91, v91, |v91|
  s_waitcnt lgkmcnt(6)
  v_mfma_f32_16x16x32_bf16 v[40:43], v[96:99], v[208:211], v[40:43]
  v_cvt_pk_bf16_f32 v18, v88, v89
  ds_read_b128 v[124:127], v29 offset:64512
  v_mfma_f32_16x16x32_bf16 v[36:39], v[96:99], v[204:207], v[36:39]
  v_cvt_pk_bf16_f32 v19, v90, v91
  s_waitcnt lgkmcnt(6)
  v_mfma_f32_16x16x32_bf16 v[48:51], v[100:103], v[152:155], v[48:51]
  v_pk_max_i16 v18, v18, 0
  ds_read_b128 v[128:131], v30 offset:6144
  v_mfma_f32_16x16x32_bf16 v[44:47], v[100:103], v[148:151], v[44:47]
  v_pk_max_i16 v19, v19, 0
  s_waitcnt lgkmcnt(6)
  v_mfma_f32_16x16x32_bf16 v[48:51], v[104:107], v[160:163], v[48:51]
  v_permlane16_swap_b32 v16, v18
  ds_read_b128 v[132:135], v29 offset:22528
  v_mfma_f32_16x16x32_bf16 v[44:47], v[104:107], v[156:159], v[44:47]
  v_permlane16_swap_b32 v17, v19
  s_waitcnt lgkmcnt(6)
  v_mfma_f32_16x16x32_bf16 v[48:51], v[108:111], v[168:171], v[48:51]
  s_cmp_ge_u32 s41, 12
  s_cbranch_scc1 K3_ns
  buffer_store_dwordx4 v[16:19], v32, s[16:19], s59 offen sc1
K3_ns:
  ds_read_b128 v[136:139], v29 offset:29696
  v_mfma_f32_16x16x32_bf16 v[44:47], v[108:111], v[164:167], v[44:47]
  v_mul_f32_e64 v36, v36, |v36|
  s_waitcnt lgkmcnt(6)
  v_mfma_f32_16x16x32_bf16 v[48:51], v[112:115], v[176:179], v[48:51]
  v_mul_f32_e64 v37, v37, |v37|
  ds_read_b128 v[140:143], v29 offset:36864
  v_mfma_f32_16x16x32_bf16 v[44:47], v[112:115], v[172:175], v[44:47]
  v_mul_f32_e64 v38, v38, |v38|
  s_waitcnt lgkmcnt(6)
  v_mfma_f32_16x16x32_bf16 v[48:51], v[116:119], v[184:187], v[48:51]
  v_mul_f32_e64 v39, v39, |v39|
  ds_read_b128 v[144:147], v29 offset:44032
  v_mfma_f32_16x16x32_bf16 v[44:47], v[116:119], v[180:183], v[44:47]
  v_cvt_pk_bf16_f32 v8, v36, v37
  s_waitcnt lgkmcnt(6)
  v_mfma_f32_16x16x32_bf16 v[48:51], v[120:123], v[192:195], v[48:51]
  v_cvt_pk_bf16_f32 v9, v38, v39
  ds_read_b128 v[92:95], v29 offset:51200
  v_mfma_f32_16x16x32_bf16 v[44:47], v[120:123], v[188:191], v[44:47]
  v_pk_max_i16 v8, v8, 0
  s_waitcnt lgkmcnt(6)
  v_mfma_f32_16x16x32_bf16 v[48:51], v[124:127], v[200:203], v[48:51]
  v_pk_max_i16 v9, v9, 0
  ds_read_b128 v[96:99], v29 offset:58368
  v_mfma_f32_16x16x32_bf16 v[44:47], v[124:127], v[196:199], v[44:47]
  v_mul_f32_e64 v40, v40, |v40|
  s_waitcnt lgkmcnt(6)
  v_mfma_f32_16x16x32_bf16 v[48:51], v[128:131], v[208:211], v[48:51]
  v_mul_f32_e64 v41, v41, |v41|
  ds_read_b128 v[100:103], v30 offset:0
  v_mfma_f32_16x16x32_bf16 v[44:47], v[128:131], v[204:207], v[44:47]
  v_mul_f32_e64 v42, v42, |v42|
  s_waitcnt lgkmcnt(6)
  v_mfma_f32_16x16x32_bf16 v[56:59], v[132:135], v[152:155], v[56:59]
  v_mul_f32_e64 v43, v43, |v43|
  ds_read_b128 v[104:107], v30 offset:7168
  v_mfma_f32_16x16x32_bf16 v[52:55], v[132:135], v[148:151], v[52:55]
  v_cvt_pk_bf16_f32 v12, v40, v41
  s_waitcnt lgkmcnt(6)
  v_mfma_f32_16x16x32_bf16 v[56:59], v[136:139], v[160:163], v[56:59]
  v_cvt_pk_bf16_f32 v13, v42, v43
  ds_read_b128 v[108:111], v29 offset:23552
  v_mfma_f32_16x16x32_bf16 v[52:55], v[136:139], v[156:159], v[52:55]
  v_pk_max_i16 v12, v12, 0
  s_waitcnt lgkmcnt(6)
  v_mfma_f32_16x16x32_bf16 v[56:59], v[140:143], v[168:171], v[56:59]
  v_pk_max_i16 v13, v13, 0
  ds_read_b128 v[112:115], v29 offset:30720
  v_mfma_f32_16x16x32_bf16 v[52:55], v[140:143], v[164:167], v[52:55]
  v_mul_f32_e64 v44, v44, |v44|
  s_waitcnt lgkmcnt(6)
  v_mfma_f32_16x16x32_bf16 v[56:59], v[144:147], v[176:179], v[56:59]
  v_mul_f32_e64 v45, v45, |v45|
  ds_read_b128 v[116:119], v29 offset:37888
  v_mfma_f32_16x16x32_bf16 v[52:55], v[144:147], v[172:175], v[52:55]
  v_mul_f32_e64 v46, v46, |v46|
  s_waitcnt lgkmcnt(6)
  v_mfma_f32_16x16x32_bf16 v[56:59], v[92:95], v[184:187], v[56:59]
  v_mul_f32_e64 v47, v47, |v47|
  ds_read_b128 v[120:123], v29 offset:45056
  v_mfma_f32_16x16x32_bf16 v[52:55], v[92:95], v[180:183], v[52:55]
  v_cvt_pk_bf16_f32 v10, v44, v45
  s_waitcnt lgkmcnt(6)
  v_mfma_f32_16x16x32_bf16 v[56:59], v[96:99], v[192:195], v[56:59]
  v_cvt_pk_bf16_f32 v11, v46, v47
  ds_read_b128 v[124:127], v29 offset:52224
  v_mfma_f32_16x16x32_bf16 v[52:55], v[96:99], v[188:191], v[52:55]
  v_pk_max_i16 v10, v10, 0
  s_waitcnt lgkmcnt(6)
  v_mfma_f32_16x16x32_bf16 v[56:59], v[100:103], v[200:203], v[56:59]
  v_pk_max_i16 v11, v11, 0
  ds_read_b128 v[128:131], v29 offset:59392
  v_mfma_f32_16x16x32_bf16 v[52:55], v[100:103], v[196:199], v[52:55]
  v_mul_f32_e64 v48, v48, |v48|
  s_waitcnt lgkmcnt(6)
  v_mfma_f32_16x16x32_bf16 v[56:59], v[104:107], v[208:211], v[56:59]
  v_mul_f32_e64 v49, v49, |v49|
  ds_read_b128 v[132:135], v30 offset:1024
  v_mfma_f32_16x16x32_bf16 v[52:55], v[104:107], v[204:207], v[52:55]
  v_mul_f32_e64 v50, v50, |v50|
  s_waitcnt lgkmcnt(6)
  v_mfma_f32_16x16x32_bf16 v[64:67], v[108:111], v[152:155], v[64:67]
  v_mul_f32_e64 v51, v51, |v51|
  ds_read_b128 v[136:139], v30 offset:8192
  v_mfma_f32_16x16x32_bf16 v[60:63], v[108:111], v[148:151], v[60:63]
  v_cvt_pk_bf16_f32 v14, v48, v49
  s_waitcnt lgkmcnt(6)
  v_mfma_f32_16x16x32_bf16 v[64:67], v[112:115], v[160:163], v[64:67]
  v_cvt_pk_bf16_f32 v15, v50, v51
  ds_read_b128 v[140:143], v29 offset:24576
  v_mfma_f32_16x16x32_bf16 v[60:63], v[112:115], v[156:159], v[60:63]
  v_pk_max_i16 v14, v14, 0
  s_waitcnt lgkmcnt(6)
  v_mfma_f32_16x16x32_bf16 v[64:67], v[116:119], v[168:171], v[64:67]
  v_pk_max_i16 v15, v15, 0
  ds_read_b128 v[144:147], v29 offset:31744
  v_mfma_f32_16x16x32_bf16 v[60:63], v[116:119], v[164:167], v[60:63]
  buffer_store_dwordx4 v[8:11], v1, s[16:19], s58 offen offset:0 sc1
  buffer_store_dwordx4 v[12:15], v1, s[16:19], s58 offen offset:1024 sc1
  s_add_u32 s58, s58, 4096
  s_waitcnt lgkmcnt(6)
  v_mfma_f32_16x16x32_bf16 v[64:67], v[120:123], v[176:179], v[64:67]
  v_mul_f32_e64 v52, v52, |v52|
  ds_read_b128 v[92:95], v29 offset:38912
  v_mfma_f32_16x16x32_bf16 v[60:63], v[120:123], v[172:175], v[60:63]
  v_mul_f32_e64 v53, v53, |v53|
  s_waitcnt lgkmcnt(6)
  v_mfma_f32_16x16x32_bf16 v[64:67], v[124:127], v[184:187], v[64:67]
  v_mul_f32_e64 v54, v54, |v54|
  ds_read_b128 v[96:99], v29 offset:46080
  v_mfma_f32_16x16x32_bf16 v[60:63], v[124:127], v[180:183], v[60:63]
  v_mul_f32_e64 v55, v55, |v55|
  s_waitcnt lgkmcnt(6)
  v_mfma_f32_16x16x32_bf16 v[64:67], v[128:131], v[192:195], v[64:67]
  v_cvt_pk_bf16_f32 v16, v52, v53
  ds_read_b128 v[100:103], v29 offset:53248
  v_mfma_f32_16x16x32_bf16 v[60:63], v[128:131], v[188:191], v[60:63]
  v_cvt_pk_bf16_f32 v17, v54, v55
  s_waitcnt lgkmcnt(6)
  v_mfma_f32_16x16x32_bf16 v[64:67], v[132:135], v[200:203], v[64:67]
  v_pk_max_i16 v16, v16, 0
  ds_read_b128 v[104:107], v29 offset:60416
  v_mfma_f32_16x16x32_bf16 v[60:63], v[132:135], v[196:199], v[60:63]
  v_pk_max_i16 v17, v17, 0
  s_waitcnt lgkmcnt(6)
  v_mfma_f32_16x16x32_bf16 v[64:67], v[136:139], v[208:211], v[64:67]
  v_mul_f32_e64 v56, v56, |v56|
  ds_read_b128 v[108:111], v30 offset:2048
  v_mfma_f32_16x16x32_bf16 v[60:63], v[136:139], v[204:207], v[60:63]
  v_mul_f32_e64 v57, v57, |v57|
  s_waitcnt lgkmcnt(6)
  v_mfma_f32_16x16x32_bf16 v[72:75], v[140:143], v[152:155], v[72:75]
  v_mul_f32_e64 v58, v58, |v58|
  ds_read_b128 v[112:115], v30 offset:9216
  v_mfma_f32_16x16x32_bf16 v[68:71], v[140:143], v[148:151], v[68:71]
  v_mul_f32_e64 v59, v59, |v59|
  s_waitcnt lgkmcnt(6)
  v_mfma_f32_16x16x32_bf16 v[72:75], v[144:147], v[160:163], v[72:75]
  v_cvt_pk_bf16_f32 v20, v56, v57
  ds_read_b128 v[116:119], v29 offset:25600
  v_mfma_f32_16x16x32_bf16 v[68:71], v[144:147], v[156:159], v[68:71]
  v_cvt_pk_bf16_f32 v21, v58, v59
  s_waitcnt lgkmcnt(6)
  v_mfma_f32_16x16x32_bf16 v[72:75], v[92:95], v[168:171], v[72:75]
  v_pk_max_i16 v20, v20, 0
  ds_read_b128 v[120:123], v29 offset:32768
  v_mfma_f32_16x16x32_bf16 v[68:71], v[92:95], v[164:167], v[68:71]
  v_pk_max_i16 v21, v21, 0
  s_waitcnt lgkmcnt(6)
  v_mfma_f32_16x16x32_bf16 v[72:75], v[96:99], v[176:179], v[72:75]
  v_mul_f32_e64 v60, v60, |v60|
  ds_read_b128 v[124:127], v29 offset:39936
  v_mfma_f32_16x16x32_bf16 v[68:71], v[96:99], v[172:175], v[68:71]
  v_mul_f32_e64 v61, v61, |v61|
  s_waitcnt lgkmcnt(6)
  v_mfma_f32_16x16x32_bf16 v[72:75], v[100:103], v[184:187], v[72:75]
  v_mul_f32_e64 v62, v62, |v62|
  ds_read_b128 v[128:131], v29 offset:47104
  v_mfma_f32_16x16x32_bf16 v[68:71], v[100:103], v[180:183], v[68:71]
  v_mul_f32_e64 v63, v63, |v63|
  s_waitcnt lgkmcnt(6)
  v_mfma_f32_16x16x32_bf16 v[72:75], v[104:107], v[192:195], v[72:75]
  v_cvt_pk_bf16_f32 v18, v60, v61
  ds_read_b128 v[132:135], v29 offset:54272
  v_mfma_f32_16x16x32_bf16 v[68:71], v[104:107], v[188:191], v[68:71]
  v_cvt_pk_bf16_f32 v19, v62, v63
  s_waitcnt lgkmcnt(6)
  v_mfma_f32_16x16x32_bf16 v[72:75], v[108:111], v[200:203], v[72:75]
  v_pk_max_i16 v18, v18, 0
  ds_read_b128 v[136:139], v29 offset:61440
  v_mfma_f32_16x16x32_bf16 v[68:71], v[108:111], v[196:199], v[68:71]
  v_pk_max_i16 v19, v19, 0
  s_waitcnt lgkmcnt(6)
  v_mfma_f32_16x16x32_bf16 v[72:75], v[112:115], v[208:211], v[72:75]
  v_mul_f32_e64 v64, v64, |v64|
  ds_read_b128 v[140:143], v30 offset:3072
  v_mfma_f32_16x16x32_bf16 v[68:71], v[112:115], v[204:207], v[68:71]
  v_mul_f32_e64 v65, v65, |v65|
  s_waitcnt lgkmcnt(6)
  v_mfma_f32_16x16x32_bf16 v[80:83], v[116:119], v[152:155], v[80:83]
  v_mul_f32_e64 v66, v66, |v66|
  ds_read_b128 v[144:147], v30 offset:10240
  v_mfma_f32_16x16x32_bf16 v[76:79], v[116:119], v[148:151], v[76:79]
  v_mul_f32_e64 v67, v67, |v67|
  s_waitcnt lgkmcnt(6)
  v_mfma_f32_16x16x32_bf16 v[80:83], v[120:123], v[160:163], v[80:83]
  v_cvt_pk_bf16_f32 v22, v64, v65
  v_mfma_f32_16x16x32_bf16 v[76:79], v[120:123], v[156:159], v[76:79]
  v_cvt_pk_bf16_f32 v23, v66, v67
  s_waitcnt lgkmcnt(5)
  v_mfma_f32_16x16x32_bf16 v[80:83], v[124:127], v[168:171], v[80:83]
  v_pk_max_i16 v22, v22, 0
  v_mfma_f32_16x16x32_bf16 v[76:79], v[124:127], v[164:167], v[76:79]
  v_pk_max_i16 v23, v23, 0
  s_waitcnt lgkmcnt(4)
  v_mfma_f32_16x16x32_bf16 v[80:83], v[128:131], v[176:179], v[80:83]
  buffer_store_dwordx4 v[16:19], v1, s[16:19], s58 offen offset:0 sc1
  buffer_store_dwordx4 v[20:23], v1, s[16:19], s58 offen offset:1024 sc1
  s_add_u32 s58, s58, 4096
  v_mfma_f32_16x16x32_bf16 v[76:79], v[128:131], v[172:175], v[76:79]
  v_mul_f32_e64 v68, v68, |v68|
  s_waitcnt lgkmcnt(3)
  v_mfma_f32_16x16x32_bf16 v[80:83], v[132:135], v[184:187], v[80:83]
  v_mul_f32_e64 v69, v69, |v69|
  v_mfma_f32_16x16x32_bf16 v[76:79], v[132:135], v[180:183], v[76:79]
  v_mul_f32_e64 v70, v70, |v70|
  s_waitcnt lgkmcnt(2)
  v_mfma_f32_16x16x32_bf16 v[80:83], v[136:139], v[192:195], v[80:83]
  v_mul_f32_e64 v71, v71, |v71|
  v_mfma_f32_16x16x32_bf16 v[76:79], v[136:139], v[188:191], v[76:79]
  v_cvt_pk_bf16_f32 v8, v68, v69
  s_waitcnt lgkmcnt(1)
  v_mfma_f32_16x16x32_bf16 v[80:83], v[140:143], v[200:203], v[80:83]
  v_cvt_pk_bf16_f32 v9, v70, v71
  v_mfma_f32_16x16x32_bf16 v[76:79], v[140:143], v[196:199], v[76:79]
  v_pk_max_i16 v8, v8, 0
  s_waitcnt lgkmcnt(0)
  v_mfma_f32_16x16x32_bf16 v[80:83], v[144:147], v[208:211], v[80:83]
  v_pk_max_i16 v9, v9, 0
  v_mfma_f32_16x16x32_bf16 v[76:79], v[144:147], v[204:207], v[76:79]
  v_mul_f32_e64 v72, v72, |v72|
  v_mul_f32_e64 v73, v73, |v73|
  v_mul_f32_e64 v74, v74, |v74|
  v_mul_f32_e64 v75, v75, |v75|
  v_cvt_pk_bf16_f32 v12, v72, v73
  v_cvt_pk_bf16_f32 v13, v74, v75
  v_pk_max_i16 v12, v12, 0
  v_pk_max_i16 v13, v13, 0
  v_mul_f32_e64 v76, v76, |v76|
  v_mul_f32_e64 v77, v77, |v77|
  v_mul_f32_e64 v78, v78, |v78|
  v_mul_f32_e64 v79, v79, |v79|
  v_cvt_pk_bf16_f32 v10, v76, v77
  v_cvt_pk_bf16_f32 v11, v78, v79
  v_pk_max_i16 v10, v10, 0
  v_pk_max_i16 v11, v11, 0
  v_mul_f32_e64 v80, v80, |v80|
  v_mul_f32_e64 v81, v81, |v81|
  v_mul_f32_e64 v82, v82, |v82|
  v_mul_f32_e64 v83, v83, |v83|
  v_cvt_pk_bf16_f32 v14, v80, v81
  v_cvt_pk_bf16_f32 v15, v82, v83
  v_pk_max_i16 v14, v14, 0
  v_pk_max_i16 v15, v15, 0
  buffer_store_dwordx4 v[8:11], v1, s[16:19], s58 offen offset:0 sc1
  buffer_store_dwordx4 v[12:15], v1, s[16:19], s58 offen offset:1024 sc1
  buffer_load_dwordx4 a[184:187], v1, s[16:19], s62 offen offset:1024 sc1
  buffer_load_dwordx4 a[188:191], v1, s[16:19], s62 offen offset:2048 sc1
  buffer_load_dwordx4 a[192:195], v1, s[16:19], s62 offen offset:3072 sc1
  buffer_load_dwordx4 a[196:199], v2, s[16:19], s62 offen offset:0 sc1
  s_add_u32 s62, s55, 204800
  buffer_load_dwordx4 a[200:203], v1, s[16:19], s62 offen offset:0 sc1
  buffer_load_dwordx4 a[204:207], v1, s[16:19], s62 offen offset:1024 sc1
  buffer_load_dwordx4 a[208:211], v1, s[16:19], s62 offen offset:2048 sc1
  buffer_load_dwordx4 a[212:215], v1, s[16:19], s62 offen offset:3072 sc1
  s_waitcnt vmcnt(8)
  s_barrier
  s_cmp_lg_u32 s45, 0
  s_cbranch_scc1 K3_nf1
  s_lshl_b32 s43, s41, 2
  s_add_u32 s43, s43, s52
  v_mov_b32 v6, 1
  v_mov_b32 v5, 0
  s_mov_b64 exec, 1
  buffer_store_dword v6, v5, s[16:19], s43 offen offset:128 sc1
  s_mov_b64 exec, -1
K3_nf1:
  buffer_load_dwordx4 a[216:219], v2, s[16:19], s62 offen offset:0 sc1
  s_add_u32 s62, s55, 266240
  buffer_load_dwordx4 a[220:223], v1, s[16:19], s62 offen offset:0 sc1
  buffer_load_dwordx4 a[224:227], v1, s[16:19], s62 offen offset:1024 sc1
  buffer_load_dwordx4 a[228:231], v1, s[16:19], s62 offen offset:2048 sc1
  buffer_load_dwordx4 a[232:235], v1, s[16:19], s62 offen offset:3072 sc1
  buffer_load_dwordx4 a[236:239], v2, s[16:19], s62 offen offset:0 sc1
  s_add_u32 s62, s55, 225280
  buffer_load_dwordx4 a[240:243], v1, s[16:19], s62 offen offset:0 sc1
  buffer_load_dwordx4 a[244:247], v1, s[16:19], s62 offen offset:1024 sc1
  buffer_load_dwordx4 a[248:251], v1, s[16:19], s62 offen offset:2048 sc1
  buffer_load_dwordx4 a[252:255], v1, s[16:19], s62 offen offset:3072 sc1
  buffer_load_dwordx4 v[28:31], v2, s[16:19], s62 offen offset:0 sc1
  s_add_u32 s62, s55, 245760
  buffer_load_dwordx4 v[32:35], v1, s[16:19], s62 offen offset:0 sc1
  buffer_load_dwordx4 v[36:39], v1, s[16:19], s62 offen offset:1024 sc1
  buffer_load_dwordx4 v[40:43], v1, s[16:19], s62 offen offset:2048 sc1
  buffer_load_dwordx4 v[44:47], v1, s[16:19], s62 offen offset:3072 sc1
  buffer_load_dwordx4 v[48:51], v2, s[16:19], s62 offen offset:0 sc1
  v_lshlrev_b32 v5, 2, v3
  s_mov_b32 s53, 0
  s_add_u32 s43, s45, 0
  s_and_b32 s43, s43, 3
  s_lshl_b32 s44, s43, 10
  v_add_u32 v8, s44, v1
  s_add_u32 s43, s45, 1
  s_and_b32 s43, s43, 3
  s_lshl_b32 s44, s43, 10
  v_add_u32 v9, s44, v1
  s_mul_i32 s44, s43, 15360
  s_add_u32 s44, s44, 21504
  v_add_u32 v12, s44, v1
  s_add_u32 s43, s45, 2
  s_and_b32 s43, s43, 3
  s_lshl_b32 s44, s43, 10
  v_add_u32 v10, s44, v1
  s_mul_i32 s44, s43, 15360
  s_add_u32 s44, s44, 26624
  v_add_u32 v13, s44, v1
  s_add_u32 s43, s45, 3
  s_and_b32 s43, s43, 3
  s_lshl_b32 s44, s43, 10
  v_add_u32 v11, s44, v1
  s_mul_i32 s44, s43, 15360
  s_add_u32 s44, s44, 31744
  v_add_u32 v14, s44, v1
  s_mul_i32 s44, s45, 15360
  s_add_u32 s44, s44, 21504
  v_add_u32 v15, s44, v1
  s_bfe_u32 s43, s2, 0x10005
  s_lshl_b32 s56, s40, 1
  s_add_u32 s56, s56, s43
  s_mul_i32 s60, s56, 54
  s_add_u32 s60, s60, s45
  s_lshl_b32 s60, s60, 12
  s_add_u32 s60, s60, 29360128
  s_mov_b32 s36, s14
  s_mov_b32 s37, s15
  s_mov_b32 s38, 2621440
  s_mov_b32 s39, 0x20000
  s_lshl_b32 s43, s56, 2
  s_add_u32 s43, s43, s45
  s_lshr_b32 s44, s43, 1
  s_lshl_b32 s44, s44, 5
  s_and_b32 s43, s43, 1
  s_lshl_b32 s43, s43, 3
  s_add_u32 s44, s44, s43
  s_mul_i32 s58, s44, 1280
  s_mul_i32 s59, s61, 160
  s_add_u32 s58, s58, s59
  v_lshlrev_b32 v25, 3, v4
  s_mul_i32 s44, s45, 2816
  v_mul_u32_u24 v23, 176, v3
  v_add3_u32 v23, v23, v25, s44
  v_lshrrev_b32 v26, 4, v1
  v_mul_u32_u24 v24, 205, v26
  v_lshrrev_b32 v24, 11, v24
  v_mul_u32_u24 v20, 10, v24
  v_sub_u32 v26, v26, v20
  v_lshlrev_b32 v26, 4, v26
  v_mul_u32_u24 v20, 176, v24
  v_add3_u32 v20, v20, v26, s44
  v_and_b32 v16, 3, v24
  v_and_b32 v132, 4, v24
  v_lshl_add_u32 v16, v132, 2, v16
  v_and_b32 v132, 8, v24
  v_lshrrev_b32 v132, 1, v132
  v_add_u32 v16, v16, v132
  v_mad_u32_u24 v16, v16, s63, v26
  v_lshrrev_b32 v26, 4, v1
  v_add_u32 v26, 64, v26
  v_mul_u32_u24 v24, 205, v26
  v_lshrrev_b32 v24, 11, v24
  v_mul_u32_u24 v21, 10, v24
  v_sub_u32 v26, v26, v21
  v_lshlrev_b32 v26, 4, v26
  v_mul_u32_u24 v21, 176, v24
  v_add3_u32 v21, v21, v26, s44
  v_and_b32 v17, 3, v24
  v_and_b32 v132, 4, v24
  v_lshl_add_u32 v17, v132, 2, v17
  v_and_b32 v132, 8, v24
  v_lshrrev_b32 v132, 1, v132
  v_add_u32 v17, v17, v132
  v_mad_u32_u24 v17, v17, s63, v26
  v_lshrrev_b32 v26, 4, v1
  v_add_u32 v26, 128, v26
  v_mul_u32_u24 v24, 205, v26
  v_lshrrev_b32 v24, 11, v24
  v_mul_u32_u24 v22, 10, v24
  v_sub_u32 v26, v26, v22
  v_lshlrev_b32 v26, 4, v26
  v_mul_u32_u24 v22, 176, v24
  v_add3_u32 v22, v22, v26, s44
  v_and_b32 v18, 3, v24
  v_and_b32 v132, 4, v24
  v_lshl_add_u32 v18, v132, 2, v18
  v_and_b32 v132, 8, v24
  v_lshrrev_b32 v132, 1, v132
  v_add_u32 v18, v18, v132
  v_mad_u32_u24 v18, v18, s63, v26
  v_bfe_u32 v26, v0, 3, 1
  v_mul_u32_u24 v24, 10240, v26
  s_mov_b32 s32, s12
  s_mov_b32 s33, s13
  s_mov_b32 s34, 1280
  s_mov_b32 s35, 0x20000
  s_lshl_b32 s43, s56, 2
  s_add_u32 s43, s43, s45
  s_mul_i32 s57, s43, 20480
  s_mul_i32 s43, s61, 1280
  s_add_u32 s57, s57, s43
  s_add_u32 s57, s57, 12582912
  v_and_b32 v26, 7, v0
  v_lshl_add_u32 v24, v26, 4, v24
  v_lshrrev_b32 v26, 1, v4
  v_lshl_add_u32 v24, v26, 7, v24
  v_and_b32 v26, 1, v4
  v_lshl_add_u32 v24, v26, 3, v24
K3_p1:
  buffer_load_dword v6, v5, s[16:19], s52 offen offset:128 sc1
  s_add_u32 s53, s53, 1
  s_cmp_gt_u32 s53, 400000
  s_waitcnt vmcnt(0)
  s_cbranch_scc1 K3_x1
  v_cmp_ne_u32 vcc, 1, v6
  s_cbranch_vccnz K3_p1
K3_x1:
  s_add_u32 s54, s60, 0
  buffer_load_dwordx4 v[132:135], v8, s[16:19], s54 offen sc1
  buffer_load_dwordx4 v[136:139], v9, s[16:19], s54 offen sc1
  buffer_load_dwordx4 v[140:143], v10, s[16:19], s54 offen sc1
  buffer_load_dwordx4 v[144:147], v11, s[16:19], s54 offen sc1
  s_add_u32 s54, s60, 16384
  buffer_load_dwordx4 v[148:151], v8, s[16:19], s54 offen sc1
  buffer_load_dwordx4 v[152:155], v9, s[16:19], s54 offen sc1
  buffer_load_dwordx4 v[156:159], v10, s[16:19], s54 offen sc1
  buffer_load_dwordx4 v[160:163], v11, s[16:19], s54 offen sc1
  s_add_u32 s54, s60, 32768
  buffer_load_dwordx4 v[164:167], v8, s[16:19], s54 offen sc1
  buffer_load_dwordx4 v[168:171], v9, s[16:19], s54 offen sc1
  buffer_load_dwordx4 v[172:175], v10, s[16:19], s54 offen sc1
  buffer_load_dwordx4 v[176:179], v11, s[16:19], s54 offen sc1
  s_add_u32 s54, s60, 49152
  buffer_load_dwordx4 v[180:183], v8, s[16:19], s54 offen sc1
  buffer_load_dwordx4 v[184:187], v9, s[16:19], s54 offen sc1
  buffer_load_dwordx4 v[188:191], v10, s[16:19], s54 offen sc1
  buffer_load_dwordx4 v[192:195], v11, s[16:19], s54 offen sc1
  s_waitcnt vmcnt(15)
  v_mfma_f32_16x16x32_bf16 v[52:55], a[0:3], v[132:135], 0
  v_mfma_f32_16x16x32_bf16 v[56:59], a[4:7], v[132:135], 0
  v_mfma_f32_16x16x32_bf16 v[60:63], a[8:11], v[132:135], 0
  v_mfma_f32_16x16x32_bf16 v[64:67], a[12:15], v[132:135], 0
  s_add_u32 s54, s60, 65536
  buffer_load_dwordx4 v[196:199], v8, s[16:19], s54 offen sc1
  v_mfma_f32_16x16x32_bf16 v[68:71], a[16:19], v[132:135], 0
  s_waitcnt vmcnt(15)
  v_mfma_f32_16x16x32_bf16 v[72:75], a[0:3], v[136:139], 0
  v_mfma_f32_16x16x32_bf16 v[76:79], a[4:7], v[136:139], 0
  v_mfma_f32_16x16x32_bf16 v[80:83], a[8:11], v[136:139], 0
  buffer_load_dwordx4 v[200:203], v9, s[16:19], s54 offen sc1
  v_mfma_f32_16x16x32_bf16 v[84:87], a[12:15], v[136:139], 0
  v_mfma_f32_16x16x32_bf16 v[88:91], a[16:19], v[136:139], 0
  s_waitcnt vmcnt(15)
  v_mfma_f32_16x16x32_bf16 v[92:95], a[0:3], v[140:143], 0
  v_mfma_f32_16x16x32_bf16 v[96:99], a[4:7], v[140:143], 0
  buffer_load_dwordx4 v[204:207], v10, s[16:19], s54 offen sc1
  v_mfma_f32_16x16x32_bf16 v[100:103], a[8:11], v[140:143], 0
  v_mfma_f32_16x16x32_bf16 v[104:107], a[12:15], v[140:143], 0
  v_mfma_f32_16x16x32_bf16 v[108:111], a[16:19], v[140:143], 0
  s_waitcnt vmcnt(15)
  v_mfma_f32_16x16x32_bf16 v[112:115], a[0:3], v[144:147], 0
  buffer_load_dwordx4 v[208:211], v11, s[16:19], s54 offen sc1
  v_mfma_f32_16x16x32_bf16 v[116:119], a[4:7], v[144:147], 0
  v_mfma_f32_16x16x32_bf16 v[120:123], a[8:11], v[144:147], 0
  v_mfma_f32_16x16x32_bf16 v[124:127], a[12:15], v[144:147], 0
  v_mfma_f32_16x16x32_bf16 v[128:131], a[16:19], v[144:147], 0
  s_add_u32 s54, s60, 81920
  buffer_load_dwordx4 v[212:215], v8, s[16:19], s54 offen sc1
  s_waitcnt vmcnt(16)
  v_mfma_f32_16x16x32_bf16 v[52:55], a[20:23], v[148:151], v[52:55]
  v_mfma_f32_16x16x32_bf16 v[56:59], a[24:27], v[148:151], v[56:59]
  v_mfma_f32_16x16x32_bf16 v[60:63], a[28:31], v[148:151], v[60:63]
  v_mfma_f32_16x16x32_bf16 v[64:67], a[32:35], v[148:151], v[64:67]
  buffer_load_dwordx4 v[216:219], v9, s[16:19], s54 offen sc1
  v_mfma_f32_16x16x32_bf16 v[68:71], a[36:39], v[148:151], v[68:71]
  s_waitcnt vmcnt(16)
  v_mfma_f32_16x16x32_bf16 v[72:75], a[20:23], v[152:155], v[72:75]
  v_mfma_f32_16x16x32_bf16 v[76:79], a[24:27], v[152:155], v[76:79]
  v_mfma_f32_16x16x32_bf16 v[80:83], a[28:31], v[152:155], v[80:83]
  buffer_load_dwordx4 v[220:223], v10, s[16:19], s54 offen sc1
  v_mfma_f32_16x16x32_bf16 v[84:87], a[32:35], v[152:155], v[84:87]
  v_mfma_f32_16x16x32_bf16 v[88:91], a[36:39], v[152:155], v[88:91]
  s_waitcnt vmcnt(16)
  v_mfma_f32_16x16x32_bf16 v[92:95], a[20:23], v[156:159], v[92:95]
  v_mfma_f32_16x16x32_bf16 v[96:99], a[24:27], v[156:159], v[96:99]
  buffer_load_dwordx4 v[224:227], v11, s[16:19], s54 offen sc1
  v_mfma_f32_16x16x32_bf16 v[100:103], a[28:31], v[156:159], v[100:103]
  v_mfma_f32_16x16x32_bf16 v[104:107], a[32:35], v[156:159], v[104:107]
  v_mfma_f32_16x16x32_bf16 v[108:111], a[36:39], v[156:159], v[108:111]
  s_waitcnt vmcnt(16)
  v_mfma_f32_16x16x32_bf16 v[112:115], a[20:23], v[160:163], v[112:115]
  s_add_u32 s54, s60, 98304
  buffer_load_dwordx4 v[132:135], v8, s[16:19], s54 offen sc1
  v_mfma_f32_16x16x32_bf16 v[116:119], a[24:27], v[160:163], v[116:119]
  v_mfma_f32_16x16x32_bf16 v[120:123], a[28:31], v[160:163], v[120:123]
  v_mfma_f32_16x16x32_bf16 v[124:127], a[32:35], v[160:163], v[124:127]
  v_mfma_f32_16x16x32_bf16 v[128:131], a[36:39], v[160:163], v[128:131]
  buffer_load_dwordx4 v[136:139], v9, s[16:19], s54 offen sc1
  s_waitcnt vmcnt(17)
  v_mfma_f32_16x16x32_bf16 v[52:55], a[40:43], v[164:167], v[52:55]
  v_mfma_f32_16x16x32_bf16 v[56:59], a[44:47], v[164:167], v[56:59]
  v_mfma_f32_16x16x32_bf16 v[60:63], a[48:51], v[164:167], v[60:63]
  v_mfma_f32_16x16x32_bf16 v[64:67], a[52:55], v[164:167], v[64:67]
  buffer_load_dwordx4 v[140:143], v10, s[16:19], s54 offen sc1
  v_mfma_f32_16x16x32_bf16 v[68:71], a[56:59], v[164:167], v[68:71]
  s_waitcnt vmcnt(17)
  v_mfma_f32_16x16x32_bf16 v[72:75], a[40:43], v[168:171], v[72:75]
  v_mfma_f32_16x16x32_bf16 v[76:79], a[44:47], v[168:171], v[76:79]
  v_mfma_f32_16x16x32_bf16 v[80:83], a[48:51], v[168:171], v[80:83]
  buffer_load_dwordx4 v[144:147], v11, s[16:19], s54 offen sc1
  v_mfma_f32_16x16x32_bf16 v[84:87], a[52:55], v[168:171], v[84:87]
  v_mfma_f32_16x16x32_bf16 v[88:91], a[56:59], v[168:171], v[88:91]
  s_waitcnt vmcnt(17)
  v_mfma_f32_16x16x32_bf16 v[92:95], a[40:43], v[172:175], v[92:95]
  v_mfma_f32_16x16x32_bf16 v[96:99], a[44:47], v[172:175], v[96:99]
  s_add_u32 s54, s60, 114688
  buffer_load_dwordx4 v[148:151], v8, s[16:19], s54 offen sc1
  v_mfma_f32_16x16x32_bf16 v[100:103], a[48:51], v[172:175], v[100:103]
  v_mfma_f32_16x16x32_bf16 v[104:107], a[52:55], v[172:175], v[104:107]
  v_mfma_f32_16x16x32_bf16 v[108:111], a[56:59], v[172:175], v[108:111]
  s_waitcnt vmcnt(17)
  v_mfma_f32_16x16x32_bf16 v[112:115], a[40:43], v[176:179], v[112:115]
  buffer_load_dwordx4 v[152:155], v9, s[16:19], s54 offen sc1
  v_mfma_f32_16x16x32_bf16 v[116:119], a[44:47], v[176:179], v[116:119]
  v_mfma_f32_16x16x32_bf16 v[120:123], a[48:51], v[176:179], v[120:123]
  v_mfma_f32_16x16x32_bf16 v[124:127], a[52:55], v[176:179], v[124:127]
  v_mfma_f32_16x16x32_bf16 v[128:131], a[56:59], v[176:179], v[128:131]
  buffer_load_dwordx4 v[156:159], v10, s[16:19], s54 offen sc1
  s_waitcnt vmcnt(18)
  v_mfma_f32_16x16x32_bf16 v[52:55], a[60:63], v[180:183], v[52:55]
  v_mfma_f32_16x16x32_bf16 v[56:59], a[64:67], v[180:183], v[56:59]
  v_mfma_f32_16x16x32_bf16 v[60:63], a[68:71], v[180:183], v[60:63]
  v_mfma_f32_16x16x32_bf16 v[64:67], a[72:75], v[180:183], v[64:67]
  buffer_load_dwordx4 v[160:163], v11, s[16:19], s54 offen sc1
  v_mfma_f32_16x16x32_bf16 v[68:71], a[76:79], v[180:183], v[68:71]
  s_waitcnt vmcnt(18)
  v_mfma_f32_16x16x32_bf16 v[72:75], a[60:63], v[184:187], v[72:75]
  v_mfma_f32_16x16x32_bf16 v[76:79], a[64:67], v[184:187], v[76:79]
  v_mfma_f32_16x16x32_bf16 v[80:83], a[68:71], v[184:187], v[80:83]
  s_add_u32 s54, s60, 131072
  buffer_load_dwordx4 v[164:167], v8, s[16:19], s54 offen sc1
  v_mfma_f32_16x16x32_bf16 v[84:87], a[72:75], v[184:187], v[84:87]
  v_mfma_f32_16x16x32_bf16 v[88:91], a[76:79], v[184:187], v[88:91]
  s_waitcnt vmcnt(18)
  v_mfma_f32_16x16x32_bf16 v[92:95], a[60:63], v[188:191], v[92:95]
  v_mfma_f32_16x16x32_bf16 v[96:99], a[64:67], v[188:191], v[96:99]
  buffer_load_dwordx4 v[168:171], v9, s[16:19], s54 offen sc1
  v_mfma_f32_16x16x32_bf16 v[100:103], a[68:71], v[188:191], v[100:103]
  v_mfma_f32_16x16x32_bf16 v[104:107], a[72:75], v[188:191], v[104:107]
  v_mfma_f32_16x16x32_bf16 v[108:111], a[76:79], v[188:191], v[108:111]
  s_waitcnt vmcnt(18)
  v_mfma_f32_16x16x32_bf16 v[112:115], a[60:63], v[192:195], v[112:115]
  buffer_load_dwordx4 v[172:175], v10, s[16:19], s54 offen sc1
  v_mfma_f32_16x16x32_bf16 v[116:119], a[64:67], v[192:195], v[116:119]
  v_mfma_f32_16x16x32_bf16 v[120:123], a[68:71], v[192:195], v[120:123]
  v_mfma_f32_16x16x32_bf16 v[124:127], a[72:75], v[192:195], v[124:127]
  v_mfma_f32_16x16x32_bf16 v[128:131], a[76:79], v[192:195], v[128:131]
  buffer_load_dwordx4 v[176:179], v11, s[16:19], s54 offen sc1
  s_waitcnt vmcnt(19)
  v_mfma_f32_16x16x32_bf16 v[52:55], a[80:83], v[196:199], v[52:55]
  v_mfma_f32_16x16x32_bf16 v[56:59], a[84:87], v[196:199], v[56:59]
  v_mfma_f32_16x16x32_bf16 v[60:63], a[88:91], v[196:199], v[60:63]
  v_mfma_f32_16x16x32_bf16 v[64:67], a[92:95], v[196:199], v[64:67]
  s_add_u32 s54, s60, 147456
  buffer_load_dwordx4 v[180:183], v8, s[16:19], s54 offen sc1
  v_mfma_f32_16x16x32_bf16 v[68:71], a[96:99], v[196:199], v[68:71]
  s_waitcnt vmcnt(19)
  v_mfma_f32_16x16x32_bf16 v[72:75], a[80:83], v[200:203], v[72:75]
  v_mfma_f32_16x16x32_bf16 v[76:79], a[84:87], v[200:203], v[76:79]
  v_mfma_f32_16x16x32_bf16 v[80:83], a[88:91], v[200:203], v[80:83]
  buffer_load_dwordx4 v[184:187], v9, s[16:19], s54 offen sc1
  v_mfma_f32_16x16x32_bf16 v[84:87], a[92:95], v[200:203], v[84:87]
  v_mfma_f32_16x16x32_bf16 v[88:91], a[96:99], v[200:203], v[88:91]
  s_waitcnt vmcnt(19)
  v_mfma_f32_16x16x32_bf16 v[92:95], a[80:83], v[204:207], v[92:95]
  v_mfma_f32_16x16x32_bf16 v[96:99], a[84:87], v[204:207], v[96:99]
  buffer_load_dwordx4 v[188:191], v10, s[16:19], s54 offen sc1
  v_mfma_f32_16x16x32_bf16 v[100:103], a[88:91], v[204:207], v[100:103]
  v_mfma_f32_16x16x32_bf16 v[104:107], a[92:95], v[204:207], v[104:107]
  v_mfma_f32_16x16x32_bf16 v[108:111], a[96:99], v[204:207], v[108:111]
  s_waitcnt vmcnt(19)
  v_mfma_f32_16x16x32_bf16 v[112:115], a[80:83], v[208:211], v[112:115]
  buffer_load_dwordx4 v[192:195], v11, s[16:19], s54 offen sc1
  v_mfma_f32_16x16x32_bf16 v[116:119], a[84:87], v[208:211], v[116:119]
  v_mfma_f32_16x16x32_bf16 v[120:123], a[88:91], v[208:211], v[120:123]
  v_mfma_f32_16x16x32_bf16 v[124:127], a[92:95], v[208:211], v[124:127]
  v_mfma_f32_16x16x32_bf16 v[128:131], a[96:99], v[208:211], v[128:131]
  s_add_u32 s54, s60, 163840
  buffer_load_dwordx4 v[196:199], v8, s[16:19], s54 offen sc1
  s_waitcnt vmcnt(20)
  v_mfma_f32_16x16x32_bf16 v[52:55], a[100:103], v[212:215], v[52:55]
  v_mfma_f32_16x16x32_bf16 v[56:59], a[104:107], v[212:215], v[56:59]
  v_mfma_f32_16x16x32_bf16 v[60:63], a[108:111], v[212:215], v[60:63]
  v_mfma_f32_16x16x32_bf16 v[64:67], a[112:115], v[212:215], v[64:67]
  buffer_load_dwordx4 v[200:203], v9, s[16:19], s54 offen sc1
  v_mfma_f32_16x16x32_bf16 v[68:71], a[116:119], v[212:215], v[68:71]
  s_waitcnt vmcnt(20)
  v_mfma_f32_16x16x32_bf16 v[72:75], a[100:103], v[216:219], v[72:75]
  v_mfma_f32_16x16x32_bf16 v[76:79], a[104:107], v[216:219], v[76:79]
  v_mfma_f32_16x16x32_bf16 v[80:83], a[108:111], v[216:219], v[80:83]
  buffer_load_dwordx4 v[204:207], v10, s[16:19], s54 offen sc1
  v_mfma_f32_16x16x32_bf16 v[84:87], a[112:115], v[216:219], v[84:87]
  v_mfma_f32_16x16x32_bf16 v[88:91], a[116:119], v[216:219], v[88:91]
  s_waitcnt vmcnt(20)
  v_mfma_f32_16x16x32_bf16 v[92:95], a[100:103], v[220:223], v[92:95]
  v_mfma_f32_16x16x32_bf16 v[96:99], a[104:107], v[220:223], v[96:99]
  buffer_load_dwordx4 v[208:211], v11, s[16:19], s54 offen sc1
  v_mfma_f32_16x16x32_bf16 v[100:103], a[108:111], v[220:223], v[100:103]
  v_mfma_f32_16x16x32_bf16 v[104:107], a[112:115], v[220:223], v[104:107]
  v_mfma_f32_16x16x32_bf16 v[108:111], a[116:119], v[220:223], v[108:111]
  s_waitcnt vmcnt(20)
  v_mfma_f32_16x16x32_bf16 v[112:115], a[100:103], v[224:227], v[112:115]
  s_add_u32 s54, s60, 212992
  buffer_load_dwordx4 v[212:215], v8, s[16:19], s54 offen sc1
  v_mfma_f32_16x16x32_bf16 v[116:119], a[104:107], v[224:227], v[116:119]
  v_mfma_f32_16x16x32_bf16 v[120:123], a[108:111], v[224:227], v[120:123]
  v_mfma_f32_16x16x32_bf16 v[124:127], a[112:115], v[224:227], v[124:127]
  v_mfma_f32_16x16x32_bf16 v[128:131], a[116:119], v[224:227], v[128:131]
  buffer_load_dwordx4 v[216:219], v9, s[16:19], s54 offen sc1
  s_waitcnt vmcnt(21)
  v_mfma_f32_16x16x32_bf16 v[52:55], a[120:123], v[132:135], v[52:55]
  v_mfma_f32_16x16x32_bf16 v[56:59], a[124:127], v[132:135], v[56:59]
  v_mfma_f32_16x16x32_bf16 v[60:63], a[128:131], v[132:135], v[60:63]
  v_mfma_f32_16x16x32_bf16 v[64:67], a[132:135], v[132:135], v[64:67]
  buffer_load_dwordx4 v[220:223], v10, s[16:19], s54 offen sc1
  v_mfma_f32_16x16x32_bf16 v[68:71], a[136:139], v[132:135], v[68:71]
  s_waitcnt vmcnt(21)
  v_mfma_f32_16x16x32_bf16 v[72:75], a[120:123], v[136:139], v[72:75]
  v_mfma_f32_16x16x32_bf16 v[76:79], a[124:127], v[136:139], v[76:79]
  v_mfma_f32_16x16x32_bf16 v[80:83], a[128:131], v[136:139], v[80:83]
  buffer_load_dwordx4 v[224:227], v11, s[16:19], s54 offen sc1
  v_mfma_f32_16x16x32_bf16 v[84:87], a[132:135], v[136:139], v[84:87]
  v_mfma_f32_16x16x32_bf16 v[88:91], a[136:139], v[136:139], v[88:91]
  s_waitcnt vmcnt(21)
  v_mfma_f32_16x16x32_bf16 v[92:95], a[120:123], v[140:143], v[92:95]
  v_mfma_f32_16x16x32_bf16 v[96:99], a[124:127], v[140:143], v[96:99]
  s_add_u32 s54, s60, 180224
  buffer_load_dwordx4 v[132:135], v8, s[16:19], s54 offen sc1
  v_mfma_f32_16x16x32_bf16 v[100:103], a[128:131], v[140:143], v[100:103]
  v_mfma_f32_16x16x32_bf16 v[104:107], a[132:135], v[140:143], v[104:107]
  v_mfma_f32_16x16x32_bf16 v[108:111], a[136:139], v[140:143], v[108:111]
  s_waitcnt vmcnt(21)
  v_mfma_f32_16x16x32_bf16 v[112:115], a[120:123], v[144:147], v[112:115]
  buffer_load_dwordx4 v[136:139], v9, s[16:19], s54 offen sc1
  v_mfma_f32_16x16x32_bf16 v[116:119], a[124:127], v[144:147], v[116:119]
  v_mfma_f32_16x16x32_bf16 v[120:123], a[128:131], v[144:147], v[120:123]
  v_mfma_f32_16x16x32_bf16 v[124:127], a[132:135], v[144:147], v[124:127]
  v_mfma_f32_16x16x32_bf16 v[128:131], a[136:139], v[144:147], v[128:131]
  buffer_load_dwordx4 v[140:143], v10, s[16:19], s54 offen sc1
  s_waitcnt vmcnt(22)
  v_mfma_f32_16x16x32_bf16 v[52:55], a[140:143], v[148:151], v[52:55]
  v_mfma_f32_16x16x32_bf16 v[56:59], a[144:147], v[148:151], v[56:59]
  v_mfma_f32_16x16x32_bf16 v[60:63], a[148:151], v[148:151], v[60:63]
  v_mfma_f32_16x16x32_bf16 v[64:67], a[152:155], v[148:151], v[64:67]
  buffer_load_dwordx4 v[144:147], v11, s[16:19], s54 offen sc1
  v_mfma_f32_16x16x32_bf16 v[68:71], a[156:159], v[148:151], v[68:71]
  s_waitcnt vmcnt(22)
  v_mfma_f32_16x16x32_bf16 v[72:75], a[140:143], v[152:155], v[72:75]
  v_mfma_f32_16x16x32_bf16 v[76:79], a[144:147], v[152:155], v[76:79]
  v_mfma_f32_16x16x32_bf16 v[80:83], a[148:151], v[152:155], v[80:83]
  s_add_u32 s54, s60, 196608
  buffer_load_dwordx4 v[148:151], v8, s[16:19], s54 offen sc1
  v_mfma_f32_16x16x32_bf16 v[84:87], a[152:155], v[152:155], v[84:87]
  v_mfma_f32_16x16x32_bf16 v[88:91], a[156:159], v[152:155], v[88:91]
  s_waitcnt vmcnt(22)
  v_mfma_f32_16x16x32_bf16 v[92:95], a[140:143], v[156:159], v[92:95]
  v_mfma_f32_16x16x32_bf16 v[96:99], a[144:147], v[156:159], v[96:99]
  buffer_load_dwordx4 v[152:155], v9, s[16:19], s54 offen sc1
  v_mfma_f32_16x16x32_bf16 v[100:103], a[148:151], v[156:159], v[100:103]
  v_mfma_f32_16x16x32_bf16 v[104:107], a[152:155], v[156:159], v[104:107]
  v_mfma_f32_16x16x32_bf16 v[108:111], a[156:159], v[156:159], v[108:111]
  s_waitcnt vmcnt(22)
  v_mfma_f32_16x16x32_bf16 v[112:115], a[140:143], v[160:163], v[112:115]
  buffer_load_dwordx4 v[156:159], v10, s[16:19], s54 offen sc1
  v_mfma_f32_16x16x32_bf16 v[116:119], a[144:147], v[160:163], v[116:119]
  v_mfma_f32_16x16x32_bf16 v[120:123], a[148:151], v[160:163], v[120:123]
  v_mfma_f32_16x16x32_bf16 v[124:127], a[152:155], v[160:163], v[124:127]
  v_mfma_f32_16x16x32_bf16 v[128:131], a[156:159], v[160:163], v[128:131]
  s_waitcnt vmcnt(22)
  v_mfma_f32_16x16x32_bf16 v[52:55], a[160:163], v[164:167], v[52:55]
  v_mfma_f32_16x16x32_bf16 v[56:59], a[164:167], v[164:167], v[56:59]
  v_mfma_f32_16x16x32_bf16 v[60:63], a[168:171], v[164:167], v[60:63]
  v_mfma_f32_16x16x32_bf16 v[64:67], a[172:175], v[164:167], v[64:67]
  buffer_load_dwordx4 v[160:163], v11, s[16:19], s54 offen sc1
  v_mfma_f32_16x16x32_bf16 v[68:71], a[176:179], v[164:167], v[68:71]
  s_waitcnt vmcnt(22)
  v_mfma_f32_16x16x32_bf16 v[72:75], a[160:163], v[168:171], v[72:75]
  v_mfma_f32_16x16x32_bf16 v[76:79], a[164:167], v[168:171], v[76:79]
  v_mfma_f32_16x16x32_bf16 v[80:83], a[168:171], v[168:171], v[80:83]
  buffer_load_dwordx2 v[228:229], v24, s[16:19], s57 offen offset:0 sc1
  v_mfma_f32_16x16x32_bf16 v[84:87], a[172:175], v[168:171], v[84:87]
  v_mfma_f32_16x16x32_bf16 v[88:91], a[176:179], v[168:171], v[88:91]
  s_waitcnt vmcnt(22)
  v_mfma_f32_16x16x32_bf16 v[92:95], a[160:163], v[172:175], v[92:95]
  v_mfma_f32_16x16x32_bf16 v[96:99], a[164:167], v[172:175], v[96:99]
  buffer_load_dwordx2 v[238:239], v25, s[32:35], s59 offen offset:0
  v_mfma_f32_16x16x32_bf16 v[100:103], a[168:171], v[172:175], v[100:103]
  v_mfma_f32_16x16x32_bf16 v[104:107], a[172:175], v[172:175], v[104:107]
  v_mfma_f32_16x16x32_bf16 v[108:111], a[176:179], v[172:175], v[108:111]
  s_waitcnt vmcnt(22)
  v_mfma_f32_16x16x32_bf16 v[112:115], a[160:163], v[176:179], v[112:115]
  buffer_load_dwordx2 v[230:231], v24, s[16:19], s57 offen offset:256 sc1
  v_mfma_f32_16x16x32_bf16 v[116:119], a[164:167], v[176:179], v[116:119]
  v_mfma_f32_16x16x32_bf16 v[120:123], a[168:171], v[176:179], v[120:123]
  v_mfma_f32_16x16x32_bf16 v[124:127], a[172:175], v[176:179], v[124:127]
  v_mfma_f32_16x16x32_bf16 v[128:131], a[176:179], v[176:179], v[128:131]
  buffer_load_dwordx2 v[240:241], v25, s[32:35], s59 offen offset:32
  s_waitcnt vmcnt(23)
  v_mfma_f32_16x16x32_bf16 v[52:55], a[180:183], v[180:183], v[52:55]
  v_mfma_f32_16x16x32_bf16 v[56:59], a[184:187], v[180:183], v[56:59]
  v_mfma_f32_16x16x32_bf16 v[60:63], a[188:191], v[180:183], v[60:63]
  v_mfma_f32_16x16x32_bf16 v[64:67], a[192:195], v[180:183], v[64:67]
  buffer_load_dwordx2 v[232:233], v24, s[16:19], s57 offen offset:512 sc1
  v_mfma_f32_16x16x32_bf16 v[68:71], a[196:199], v[180:183], v[68:71]
  s_waitcnt vmcnt(23)
  v_mfma_f32_16x16x32_bf16 v[72:75], a[180:183], v[184:187], v[72:75]
  v_mfma_f32_16x16x32_bf16 v[76:79], a[184:187], v[184:187], v[76:79]
  v_mfma_f32_16x16x32_bf16 v[80:83], a[188:191], v[184:187], v[80:83]
  buffer_load_dwordx2 v[242:243], v25, s[32:35], s59 offen offset:64
  v_mfma_f32_16x16x32_bf16 v[84:87], a[192:195], v[184:187], v[84:87]
  v_mfma_f32_16x16x32_bf16 v[88:91], a[196:199], v[184:187], v[88:91]
  s_waitcnt vmcnt(23)
  v_mfma_f32_16x16x32_bf16 v[92:95], a[180:183], v[188:191], v[92:95]
  v_mfma_f32_16x16x32_bf16 v[96:99], a[184:187], v[188:191], v[96:99]
  buffer_load_dwordx2 v[234:235], v24, s[16:19], s57 offen offset:768 sc1
  v_mfma_f32_16x16x32_bf16 v[100:103], a[188:191], v[188:191], v[100:103]
  v_mfma_f32_16x16x32_bf16 v[104:107], a[192:195], v[188:191], v[104:107]
  v_mfma_f32_16x16x32_bf16 v[108:111], a[196:199], v[188:191], v[108:111]
  s_waitcnt vmcnt(23)
  v_mfma_f32_16x16x32_bf16 v[112:115], a[180:183], v[192:195], v[112:115]
  buffer_load_dwordx2 v[244:245], v25, s[32:35], s59 offen offset:96
  v_mfma_f32_16x16x32_bf16 v[116:119], a[184:187], v[192:195], v[116:119]
  v_mfma_f32_16x16x32_bf16 v[120:123], a[188:191], v[192:195], v[120:123]
  v_mfma_f32_16x16x32_bf16 v[124:127], a[192:195], v[192:195], v[124:127]
  v_mfma_f32_16x16x32_bf16 v[128:131], a[196:199], v[192:195], v[128:131]
  buffer_load_dwordx2 v[236:237], v24, s[16:19], s57 offen offset:1024 sc1
  s_waitcnt vmcnt(24)
  v_mfma_f32_16x16x32_bf16 v[52:55], a[200:203], v[196:199], v[52:55]
  v_mfma_f32_16x16x32_bf16 v[56:59], a[204:207], v[196:199], v[56:59]
  v_mfma_f32_16x16x32_bf16 v[60:63], a[208:211], v[196:199], v[60:63]
  v_mfma_f32_16x16x32_bf16 v[64:67], a[212:215], v[196:199], v[64:67]
  buffer_load_dwordx2 v[246:247], v25, s[32:35], s59 offen offset:128
  v_mfma_f32_16x16x32_bf16 v[68:71], a[216:219], v[196:199], v[68:71]
  s_waitcnt vmcnt(24)
  v_mfma_f32_16x16x32_bf16 v[72:75], a[200:203], v[200:203], v[72:75]
  v_mfma_f32_16x16x32_bf16 v[76:79], a[204:207], v[200:203], v[76:79]
  v_mfma_f32_16x16x32_bf16 v[80:83], a[208:211], v[200:203], v[80:83]
  v_mfma_f32_16x16x32_bf16 v[84:87], a[212:215], v[200:203], v[84:87]
  v_mfma_f32_16x16x32_bf16 v[88:91], a[216:219], v[200:203], v[88:91]
  s_waitcnt vmcnt(23)
  v_mfma_f32_16x16x32_bf16 v[92:95], a[200:203], v[204:207], v[92:95]
  v_mfma_f32_16x16x32_bf16 v[96:99], a[204:207], v[204:207], v[96:99]
  v_mfma_f32_16x16x32_bf16 v[100:103], a[208:211], v[204:207], v[100:103]
  v_mfma_f32_16x16x32_bf16 v[104:107], a[212:215], v[204:207], v[104:107]
  v_mfma_f32_16x16x32_bf16 v[108:111], a[216:219], v[204:207], v[108:111]
  s_waitcnt vmcnt(22)
  v_mfma_f32_16x16x32_bf16 v[112:115], a[200:203], v[208:211], v[112:115]
  v_mfma_f32_16x16x32_bf16 v[116:119], a[204:207], v[208:211], v[116:119]
  v_mfma_f32_16x16x32_bf16 v[120:123], a[208:211], v[208:211], v[120:123]
  v_mfma_f32_16x16x32_bf16 v[124:127], a[212:215], v[208:211], v[124:127]
  v_mfma_f32_16x16x32_bf16 v[128:131], a[216:219], v[208:211], v[128:131]
  s_cmp_ge_u32 s45, 2
  s_cbranch_scc1 K3_sk
  s_waitcnt vmcnt(21)
  v_mfma_f32_16x16x32_bf16 v[52:55], a[220:223], v[212:215], v[52:55]
  v_mfma_f32_16x16x32_bf16 v[56:59], a[224:227], v[212:215], v[56:59]
  v_mfma_f32_16x16x32_bf16 v[60:63], a[228:231], v[212:215], v[60:63]
  v_mfma_f32_16x16x32_bf16 v[64:67], a[232:235], v[212:215], v[64:67]
  v_mfma_f32_16x16x32_bf16 v[68:71], a[236:239], v[212:215], v[68:71]
  s_waitcnt vmcnt(20)
  v_mfma_f32_16x16x32_bf16 v[72:75], a[220:223], v[216:219], v[72:75]
  v_mfma_f32_16x16x32_bf16 v[76:79], a[224:227], v[216:219], v[76:79]
  v_mfma_f32_16x16x32_bf16 v[80:83], a[228:231], v[216:219], v[80:83]
  v_mfma_f32_16x16x32_bf16 v[84:87], a[232:235], v[216:219], v[84:87]
  v_mfma_f32_16x16x32_bf16 v[88:91], a[236:239], v[216:219], v[88:91]
  s_waitcnt vmcnt(19)
  v_mfma_f32_16x16x32_bf16 v[92:95], a[220:223], v[220:223], v[92:95]
  v_mfma_f32_16x16x32_bf16 v[96:99], a[224:227], v[220:223], v[96:99]
  v_mfma_f32_16x16x32_bf16 v[100:103], a[228:231], v[220:223], v[100:103]
  v_mfma_f32_16x16x32_bf16 v[104:107], a[232:235], v[220:223], v[104:107]
  v_mfma_f32_16x16x32_bf16 v[108:111], a[236:239], v[220:223], v[108:111]
  s_waitcnt vmcnt(18)
  v_mfma_f32_16x16x32_bf16 v[112:115], a[220:223], v[224:227], v[112:115]
  v_mfma_f32_16x16x32_bf16 v[116:119], a[224:227], v[224:227], v[116:119]
  v_mfma_f32_16x16x32_bf16 v[120:123], a[228:231], v[224:227], v[120:123]
  v_mfma_f32_16x16x32_bf16 v[124:127], a[232:235], v[224:227], v[124:127]
  v_mfma_f32_16x16x32_bf16 v[128:131], a[236:239], v[224:227], v[128:131]
K3_sk:
  s_waitcnt vmcnt(16)
  v_mfma_f32_16x16x32_bf16 v[72:75], a[240:243], v[136:139], v[72:75]
  v_mfma_f32_16x16x32_bf16 v[76:79], a[244:247], v[136:139], v[76:79]
  v_mfma_f32_16x16x32_bf16 v[80:83], a[248:251], v[136:139], v[80:83]
  v_mfma_f32_16x16x32_bf16 v[84:87], a[252:255], v[136:139], v[84:87]
  v_mfma_f32_16x16x32_bf16 v[88:91], v[28:31], v[136:139], v[88:91]
  s_waitcnt vmcnt(12)
  v_mfma_f32_16x16x32_bf16 v[72:75], v[32:35], v[152:155], v[72:75]
  v_mfma_f32_16x16x32_bf16 v[76:79], v[36:39], v[152:155], v[76:79]
  v_mfma_f32_16x16x32_bf16 v[80:83], v[40:43], v[152:155], v[80:83]
  v_mfma_f32_16x16x32_bf16 v[84:87], v[44:47], v[152:155], v[84:87]
  v_mfma_f32_16x16x32_bf16 v[88:91], v[48:51], v[152:155], v[88:91]
  s_waitcnt vmcnt(15)
  v_mfma_f32_16x16x32_bf16 v[92:95], a[240:243], v[140:143], v[92:95]
  v_mfma_f32_16x16x32_bf16 v[96:99], a[244:247], v[140:143], v[96:99]
  s_nop 0
  ds_write_b128 v12, v[72:75] offset:0
  v_mfma_f32_16x16x32_bf16 v[100:103], a[248:251], v[140:143], v[100:103]
  v_mfma_f32_16x16x32_bf16 v[104:107], a[252:255], v[140:143], v[104:107]
  ds_write_b128 v12, v[76:79] offset:1024
  v_mfma_f32_16x16x32_bf16 v[108:111], v[28:31], v[140:143], v[108:111]
  s_waitcnt vmcnt(11)
  v_mfma_f32_16x16x32_bf16 v[92:95], v[32:35], v[156:159], v[92:95]
  ds_write_b128 v12, v[80:83] offset:2048
  v_mfma_f32_16x16x32_bf16 v[96:99], v[36:39], v[156:159], v[96:99]
  v_mfma_f32_16x16x32_bf16 v[100:103], v[40:43], v[156:159], v[100:103]
  ds_write_b128 v12, v[84:87] offset:3072
  v_mfma_f32_16x16x32_bf16 v[104:107], v[44:47], v[156:159], v[104:107]
  v_mfma_f32_16x16x32_bf16 v[108:111], v[48:51], v[156:159], v[108:111]
  ds_write_b128 v12, v[88:91] offset:4096
  s_waitcnt vmcnt(14)
  v_mfma_f32_16x16x32_bf16 v[112:115], a[240:243], v[144:147], v[112:115]
  v_mfma_f32_16x16x32_bf16 v[116:119], a[244:247], v[144:147], v[116:119]
  ds_write_b128 v13, v[92:95] offset:0
  v_mfma_f32_16x16x32_bf16 v[120:123], a[248:251], v[144:147], v[120:123]
  v_mfma_f32_16x16x32_bf16 v[124:127], a[252:255], v[144:147], v[124:127]
  ds_write_b128 v13, v[96:99] offset:1024
  v_mfma_f32_16x16x32_bf16 v[128:131], v[28:31], v[144:147], v[128:131]
  s_waitcnt vmcnt(10)
  v_mfma_f32_16x16x32_bf16 v[112:115], v[32:35], v[160:163], v[112:115]
  ds_write_b128 v13, v[100:103] offset:2048
  v_mfma_f32_16x16x32_bf16 v[116:119], v[36:39], v[160:163], v[116:119]
  v_mfma_f32_16x16x32_bf16 v[120:123], v[40:43], v[160:163], v[120:123]
  ds_write_b128 v13, v[104:107] offset:3072
  v_mfma_f32_16x16x32_bf16 v[124:127], v[44:47], v[160:163], v[124:127]
  v_mfma_f32_16x16x32_bf16 v[128:131], v[48:51], v[160:163], v[128:131]
  ds_write_b128 v13, v[108:111] offset:4096
  s_waitcnt vmcnt(17)
  v_mfma_f32_16x16x32_bf16 v[52:55], a[240:243], v[132:135], v[52:55]
  v_mfma_f32_16x16x32_bf16 v[56:59], a[244:247], v[132:135], v[56:59]
  ds_write_b128 v14, v[112:115] offset:0
  v_mfma_f32_16x16x32_bf16 v[60:63], a[248:251], v[132:135], v[60:63]
  v_mfma_f32_16x16x32_bf16 v[64:67], a[252:255], v[132:135], v[64:67]
  ds_write_b128 v14, v[116:119] offset:1024
  v_mfma_f32_16x16x32_bf16 v[68:71], v[28:31], v[132:135], v[68:71]
  s_waitcnt vmcnt(13)
  v_mfma_f32_16x16x32_bf16 v[52:55], v[32:35], v[148:151], v[52:55]
  ds_write_b128 v14, v[120:123] offset:2048
  v_mfma_f32_16x16x32_bf16 v[56:59], v[36:39], v[148:151], v[56:59]
  v_mfma_f32_16x16x32_bf16 v[60:63], v[40:43], v[148:151], v[60:63]
  ds_write_b128 v14, v[124:127] offset:3072
  v_mfma_f32_16x16x32_bf16 v[64:67], v[44:47], v[148:151], v[64:67]
  v_mfma_f32_16x16x32_bf16 v[68:71], v[48:51], v[148:151], v[68:71]
  ds_write_b128 v14, v[128:131] offset:4096
  s_waitcnt vmcnt(0)
  v_lshlrev_b32 v192, 16, v228
  v_and_b32 v193, 0xffff0000, v228
  v_lshlrev_b32 v194, 16, v229
  v_and_b32 v195, 0xffff0000, v229
  v_lshlrev_b32 v196, 16, v230
  v_and_b32 v197, 0xffff0000, v230
  v_lshlrev_b32 v198, 16, v231
  v_and_b32 v199, 0xffff0000, v231
  v_lshlrev_b32 v200, 16, v232
  v_and_b32 v201, 0xffff0000, v232
  v_lshlrev_b32 v202, 16, v233
  v_and_b32 v203, 0xffff0000, v233
  v_lshlrev_b32 v204, 16, v234
  v_and_b32 v205, 0xffff0000, v234
  v_lshlrev_b32 v206, 16, v235
  v_and_b32 v207, 0xffff0000, v235
  v_lshlrev_b32 v208, 16, v236
  v_and_b32 v209, 0xffff0000, v236
  v_lshlrev_b32 v210, 16, v237
  v_and_b32 v211, 0xffff0000, v237
  s_waitcnt lgkmcnt(0)
  s_barrier
  ds_read_b128 v[132:135], v15 offset:0
  ds_read_b128 v[136:139], v15 offset:1024
  ds_read_b128 v[140:143], v15 offset:2048
  ds_read_b128 v[144:147], v15 offset:3072
  ds_read_b128 v[148:151], v15 offset:4096
  ds_read_b128 v[152:155], v15 offset:5120
  ds_read_b128 v[156:159], v15 offset:6144
  ds_read_b128 v[160:163], v15 offset:7168
  ds_read_b128 v[164:167], v15 offset:8192
  ds_read_b128 v[168:171], v15 offset:9216
  ds_read_b128 v[172:175], v15 offset:10240
  ds_read_b128 v[176:179], v15 offset:11264
  ds_read_b128 v[180:183], v15 offset:12288
  ds_read_b128 v[184:187], v15 offset:13312
  ds_read_b128 v[188:191], v15 offset:14336
  v_pk_add_f32 v[52:53], v[52:53], v[192:193]
  v_pk_add_f32 v[54:55], v[54:55], v[194:195]
  v_pk_add_f32 v[56:57], v[56:57], v[196:197]
  v_pk_add_f32 v[58:59], v[58:59], v[198:199]
  v_pk_add_f32 v[60:61], v[60:61], v[200:201]
  v_pk_add_f32 v[62:63], v[62:63], v[202:203]
  v_pk_add_f32 v[64:65], v[64:65], v[204:205]
  v_pk_add_f32 v[66:67], v[66:67], v[206:207]
  v_pk_add_f32 v[68:69], v[68:69], v[208:209]
  v_pk_add_f32 v[70:71], v[70:71], v[210:211]
  v_lshlrev_b32 v192, 16, v238
  v_and_b32 v193, 0xffff0000, v238
  v_lshlrev_b32 v194, 16, v239
  v_and_b32 v195, 0xffff0000, v239
  v_lshlrev_b32 v196, 16, v240
  v_and_b32 v197, 0xffff0000, v240
  v_lshlrev_b32 v198, 16, v241
  v_and_b32 v199, 0xffff0000, v241
  v_lshlrev_b32 v200, 16, v242
  v_and_b32 v201, 0xffff0000, v242
  v_lshlrev_b32 v202, 16, v243
  v_and_b32 v203, 0xffff0000, v243
  v_lshlrev_b32 v204, 16, v244
  v_and_b32 v205, 0xffff0000, v244
  v_lshlrev_b32 v206, 16, v245
  v_and_b32 v207, 0xffff0000, v245
  v_lshlrev_b32 v208, 16, v246
  v_and_b32 v209, 0xffff0000, v246
  v_lshlrev_b32 v210, 16, v247
  v_and_b32 v211, 0xffff0000, v247
  v_pk_add_f32 v[52:53], v[52:53], v[192:193]
  v_pk_add_f32 v[54:55], v[54:55], v[194:195]
  v_pk_add_f32 v[56:57], v[56:57], v[196:197]
  v_pk_add_f32 v[58:59], v[58:59], v[198:199]
  v_pk_add_f32 v[60:61], v[60:61], v[200:201]
  v_pk_add_f32 v[62:63], v[62:63], v[202:203]
  v_pk_add_f32 v[64:65], v[64:65], v[204:205]
  v_pk_add_f32 v[66:67], v[66:67], v[206:207]
  v_pk_add_f32 v[68:69], v[68:69], v[208:209]
  v_pk_add_f32 v[70:71], v[70:71], v[210:211]
  s_waitcnt lgkmcnt(10)
  v_pk_add_f32 v[52:53], v[52:53], v[132:133]
  v_pk_add_f32 v[54:55], v[54:55], v[134:135]
  v_pk_add_f32 v[56:57], v[56:57], v[136:137]
  v_pk_add_f32 v[58:59], v[58:59], v[138:139]
  v_pk_add_f32 v[60:61], v[60:61], v[140:141]
  v_pk_add_f32 v[62:63], v[62:63], v[142:143]
  v_pk_add_f32 v[64:65], v[64:65], v[144:145]
  v_pk_add_f32 v[66:67], v[66:67], v[146:147]
  v_pk_add_f32 v[68:69], v[68:69], v[148:149]
  v_pk_add_f32 v[70:71], v[70:71], v[150:151]
  s_waitcnt lgkmcnt(5)
  v_pk_add_f32 v[52:53], v[52:53], v[152:153]
  v_pk_add_f32 v[54:55], v[54:55], v[154:155]
  v_pk_add_f32 v[56:57], v[56:57], v[156:157]
  v_pk_add_f32 v[58:59], v[58:59], v[158:159]
  v_pk_add_f32 v[60:61], v[60:61], v[160:161]
  v_pk_add_f32 v[62:63], v[62:63], v[162:163]
  v_pk_add_f32 v[64:65], v[64:65], v[164:165]
  v_pk_add_f32 v[66:67], v[66:67], v[166:167]
  v_pk_add_f32 v[68:69], v[68:69], v[168:169]
  v_pk_add_f32 v[70:71], v[70:71], v[170:171]
  s_waitcnt lgkmcnt(4)
  v_pk_add_f32 v[52:53], v[52:53], v[172:173]
  v_pk_add_f32 v[54:55], v[54:55], v[174:175]
  v_cvt_pk_bf16_f32 v228, v52, v53
  v_cvt_pk_bf16_f32 v229, v54, v55
  ds_write_b64 v23, v[228:229] offset:0
  s_waitcnt lgkmcnt(4)
  v_pk_add_f32 v[56:57], v[56:57], v[176:177]
  v_pk_add_f32 v[58:59], v[58:59], v[178:179]
  v_cvt_pk_bf16_f32 v230, v56, v57
  v_cvt_pk_bf16_f32 v231, v58, v59
  ds_write_b64 v23, v[230:231] offset:32
  s_waitcnt lgkmcnt(4)
  v_pk_add_f32 v[60:61], v[60:61], v[180:181]
  v_pk_add_f32 v[62:63], v[62:63], v[182:183]
  v_cvt_pk_bf16_f32 v232, v60, v61
  v_cvt_pk_bf16_f32 v233, v62, v63
  ds_write_b64 v23, v[232:233] offset:64
  s_waitcnt lgkmcnt(4)
  v_pk_add_f32 v[64:65], v[64:65], v[184:185]
  v_pk_add_f32 v[66:67], v[66:67], v[186:187]
  v_cvt_pk_bf16_f32 v234, v64, v65
  v_cvt_pk_bf16_f32 v235, v66, v67
  ds_write_b64 v23, v[234:235] offset:96
  s_waitcnt lgkmcnt(4)
  v_pk_add_f32 v[68:69], v[68:69], v[188:189]
  v_pk_add_f32 v[70:71], v[70:71], v[190:191]
  v_cvt_pk_bf16_f32 v236, v68, v69
  v_cvt_pk_bf16_f32 v237, v70, v71
  ds_write_b64 v23, v[236:237] offset:128
  s_waitcnt lgkmcnt(0)
  ds_read_b128 v[132:135], v20
  ds_read_b128 v[136:139], v21
  ds_read_b128 v[140:143], v22
  s_waitcnt lgkmcnt(2)
  buffer_store_dwordx4 v[132:135], v16, s[36:39], s58 offen
  s_waitcnt lgkmcnt(1)
  buffer_store_dwordx4 v[136:139], v17, s[36:39], s58 offen
  s_waitcnt lgkmcnt(0)
  s_mov_b32 exec_lo, 0xffffffff
  s_mov_b32 exec_hi, 0x00000000
  buffer_store_dwordx4 v[140:143], v18, s[36:39], s58 offen
K3_done:
  s_endpgm

text_end:
.section .rodata,"a"
.p2align 6
.amdhsa_kernel k1_kernel
  .amdhsa_next_free_vgpr 168
  .amdhsa_next_free_sgpr 102
  .amdhsa_accum_offset 168
  .amdhsa_group_segment_fixed_size 0
  .amdhsa_kernarg_size 88
  .amdhsa_user_sgpr_count 2
  .amdhsa_user_sgpr_kernarg_segment_ptr 1
  .amdhsa_system_sgpr_workgroup_id_x 1
  .amdhsa_float_denorm_mode_32 3
.end_amdhsa_kernel

.p2align 6
.amdhsa_kernel k3_kernel
  .amdhsa_next_free_vgpr 508
  .amdhsa_next_free_sgpr 102
  .amdhsa_accum_offset 252
  .amdhsa_group_segment_fixed_size 0
  .amdhsa_kernarg_size 88
  .amdhsa_user_sgpr_count 2
  .amdhsa_user_sgpr_kernarg_segment_ptr 1
  .amdhsa_system_sgpr_workgroup_id_x 1
  .amdhsa_float_denorm_mode_32 3
.end_amdhsa_kernel
```
